```python
import torch

def _softmax(x, axis=-1):
    return torch.softmax(x, dim=axis)
def _gelu(x):
    return torch.nn.functional.gelu(x, approximate="tanh")
def _silu(x):
    return torch.nn.functional.silu(x)
def _sigmoid(x):
    return torch.sigmoid(x)
def _layernorm(x, axis=-1, eps=1e-5):
    m = x.mean(dim=axis, keepdim=True)
    v = x.var(dim=axis, keepdim=True, unbiased=False)
    return (x - m) / torch.sqrt(v + eps)
def _scatter_add(tgt, idx, src, axis=0):
    return tgt.clone().index_add_(axis, idx, src)
def _segment_sum(src, seg, n):
    out = torch.zeros((n,) + src.shape[1:], dtype=src.dtype)
    return out.index_add_(0, seg, src)
def _pad(x, pw):
    flat = tuple(v for pair in reversed(pw) for v in pair)
    return torch.nn.functional.pad(x, flat)

kernel_name = 'standalone__mha_softmax__near_ridge'

def setup_inputs():

    _w = (lambda a: (lambda t: t.to(torch.bfloat16) if t.is_floating_point() else t)(torch.as_tensor(a)))
    B, H, Sq, Sk, D = 8, 16, 368, 512, 256
    return {
        "q": _w((lambda *s: torch.randn(*s, dtype=torch.bfloat16) * 0.8)(B, H, Sq, D)),
        "k": _w((lambda *s: torch.randn(*s, dtype=torch.bfloat16) * 0.8)(B, H, Sk, D)),
        "v": _w((lambda *s: torch.randn(*s, dtype=torch.bfloat16) * 0.05)(B, H, Sk, D)),
    }

def reference(q, k, v):
    scale = q.shape[-1] ** -0.5
    scores = torch.einsum("bhqd,bhkd->bhqk", q, k) * scale
    p = _softmax(scores, axis=-1)
    return torch.einsum("bhqk,bhkd->bhqd", p, v)
```

```asm
; @launch grid=(256,1,1) block=(256,1,1) lds=163840
.amdgcn_target "amdgcn-amd-amdhsa--gfx950"
.text
.globl standalone__mha_softmax__near_ridge_kernel
.p2align 8
.type standalone__mha_softmax__near_ridge_kernel,@function
standalone__mha_softmax__near_ridge_kernel:
    s_cmp_ge_u32 s2, 256
    s_cbranch_scc1 L_end
    s_load_dwordx4 s[4:7], s[0:1], 0
    s_load_dwordx4 s[8:11], s[0:1], 16
    v_lshrrev_b32 v1, 6, v0
    s_getpc_b64 s[68:69]
L_pc:
    v_readfirstlane_b32 s28, v1
    s_bfe_u32 s66, s2, 0x30003
    s_lshl_b32 s66, s66, 12
    s_add_u32 s66, s66, L_body-L_pc
    v_and_b32 v1, 0xf8, v0
    v_lshl_add_u32 v9, v1, 4, s66
    global_load_dword a255, v9, s[68:69]
    v_and_b32 v0, 63, v0
    s_mov_b32 s37, 0
L_restart:
    s_and_b32 s64, s2, 7
    s_lshr_b32 s65, s2, 4
    s_lshl3_add_u32 s64, s65, s64
    s_lshl_b32 s67, s64, 18
    s_lshl_b32 s29, s28, 12
    v_lshrrev_b32 v1, 5, v0
    v_and_b32 v3, 31, v0
    v_xor_b32 v3, v3, v1
    v_lshlrev_b32 v3, 4, v3
    v_lshl_or_b32 v3, v1, 9, v3
    s_mul_i32 s70, s28, 0x1080
    s_and_b32 s70, s70, 0x3080
    v_xor_b32 v52, s70, v3
    v_xor_b32 v53, 32, v52
    v_xor_b32 v54, 64, v52
    v_xor_b32 v55, 96, v52
    s_mov_b32 s18, 262144
    s_mov_b32 s19, 0x20000
    s_add_u32 m0, s29, 0
    s_mov_b32 s36, 0
    s_waitcnt lgkmcnt(0)
    s_add_u32 s16, s6, s67
    s_addc_u32 s17, s7, 0
    buffer_load_dwordx4 v52, s[16:19], s36 offen offset:0 nt lds
    buffer_load_dwordx4 v53, s[16:19], s36 offen offset:1024 nt lds
    buffer_load_dwordx4 v54, s[16:19], s36 offen offset:2048 nt lds
    buffer_load_dwordx4 v55, s[16:19], s36 offen offset:3072 nt lds
    s_add_u32 m0, s29, 16384
    s_mov_b32 s36, 16384
    buffer_load_dwordx4 v52, s[16:19], s36 offen offset:0 nt lds
    buffer_load_dwordx4 v53, s[16:19], s36 offen offset:1024 nt lds
    buffer_load_dwordx4 v54, s[16:19], s36 offen offset:2048 nt lds
    buffer_load_dwordx4 v55, s[16:19], s36 offen offset:3072 nt lds
    s_bfe_u32 s65, s2, 0x10003
    s_lshl2_add_u32 s65, s65, s28
    s_mul_i32 s30, s65, 24576
    s_add_u32 s31, s30, 4096
    v_and_b32 v4, 7, v0
    v_lshrrev_b32 v2, 4, v0
    v_lshrrev_b32 v6, 3, v0
    v_xor_b32 v3, v4, v2
    v_lshlrev_b32 v3, 4, v3
    v_lshl_or_b32 v240, v6, 9, v3
    v_xor_b32 v241, 64, v240
    s_mul_i32 s66, s64, 188416
    s_mov_b32 s14, 188416
    s_mov_b32 s15, 0x20000
    s_add_u32 s12, s4, s66
    s_addc_u32 s13, s5, 0
    s_add_u32 m0, s29, 65536
    s_nop 0
    buffer_load_dwordx4 v240, s[12:15], s30 offen offset:0 nt lds
    s_add_u32 m0, s29, 66560
    s_nop 0
    buffer_load_dwordx4 v241, s[12:15], s31 offen offset:0 nt lds
    s_add_u32 s32, s30, 8192
    s_add_u32 s33, s30, 12288
    s_add_u32 s34, s30, 16384
    s_add_u32 s35, s30, 20480
    s_add_u32 s20, s8, s67
    s_addc_u32 s21, s9, 0
    s_add_u32 s24, s10, s66
    s_addc_u32 s25, s11, 0
    s_mov_b32 s22, 262144
    s_mov_b32 s23, 0x20000
    s_mov_b32 s26, 188416
    s_mov_b32 s27, 0x20000
    s_mov_b32 s38, 0x3db8aa3b
    s_mov_b32 s39, 0x3db8aa3b
    s_cmp_lg_u32 s37, 0
    s_cbranch_scc1 L_keepm
    v_mov_b32 v252, 0xff800000
    v_mov_b32 v253, 0xff800000
    s_cmp_eq_u32 s65, 7
    s_mov_b32 s65, 0xff800000
    s_cselect_b32 s65, 0x4e800000, s65
    v_mov_b32 v254, s65
L_keepm:
    v_and_b32 v1, 15, v0
    v_xor_b32 v3, v1, v2
    v_lshlrev_b32 v3, 4, v3
    v_lshl_or_b32 v28, v1, 9, v3
    v_xor_b32 v29, 64, v28
    v_xor_b32 v30, 128, v28
    v_xor_b32 v31, 192, v28
    v_add_u32 v32, 0x10000, v28
    v_add_u32 v33, 0x10000, v29
    v_add_u32 v34, 0x10000, v30
    v_add_u32 v35, 0x10000, v31
    v_add_u32 v36, 0x20000, v28
    v_add_u32 v37, 0x20000, v29
    v_add_u32 v38, 0x20000, v30
    v_add_u32 v39, 0x20000, v31
    v_lshrrev_b32 v3, 1, v1
    v_xor_b32 v3, v3, v2
    v_lshlrev_b32 v3, 4, v3
    v_lshl_or_b32 v3, v1, 7, v3
    s_add_u32 s66, s29, 65536
    v_add_u32 v242, s66, v3
    v_xor_b32 v243, 64, v242
    s_waitcnt vmcnt(8)
    s_waitcnt vmcnt(6)
    s_add_u32 m0, s29, 67456
    s_nop 0
    buffer_load_dwordx4 v240, s[12:15], s30 offen offset:128 nt lds
    s_add_u32 m0, s29, 68480
    s_nop 0
    buffer_load_dwordx4 v241, s[12:15], s31 offen offset:128 nt lds
    s_branch L_body
.p2align 12
L_body:
    v_lshlrev_b32 v5, 4, v4
    v_lshl_or_b32 v8, v6, 9, v5
    v_lshlrev_b32 v5, 5, v2
    v_xor_b32 v5, v5, v8
    s_lshl_b32 s66, s28, 14
    v_add_u32 v56, s66, v5
    v_add_u32 v57, 0xc00, v56
    v_add_u32 v58, 0x1800, v56
    v_add_u32 v59, 0x2400, v56
    v_lshrrev_b32 v5, 2, v0
    v_and_b32 v7, 3, v6
    v_lshlrev_b32 v7, 5, v7
    v_lshl_or_b32 v8, v5, 7, v7
    v_and_b32 v7, 3, v0
    v_lshl_or_b32 v40, v7, 3, v8
    v_xor_b32 v41, 32, v40
    v_xor_b32 v42, 64, v40
    v_xor_b32 v43, 96, v40
    v_add_u32 v44, 0x10000, v40
    v_add_u32 v45, 0x10000, v41
    v_add_u32 v46, 0x10000, v42
    v_add_u32 v47, 0x10000, v43
    v_add_u32 v48, 0x20000, v40
    v_add_u32 v49, 0x20000, v41
    v_add_u32 v50, 0x20000, v42
    v_add_u32 v51, 0x20000, v43
    v_lshrrev_b32 v5, 1, v1
    v_lshlrev_b32 v5, 10, v5
    v_and_b32 v7, 1, v1
    v_lshl_or_b32 v5, v7, 6, v5
    v_and_b32 v7, 1, v2
    v_lshl_or_b32 v5, v7, 5, v5
    v_lshrrev_b32 v7, 1, v2
    v_lshl_or_b32 v63, v7, 4, v5
    s_lshl_b32 s65, s28, 2
    s_add_u32 s65, s65, 48128
    s_mov_b32 s3, 0xffff0000
    s_bfe_u32 s68, s2, 0x20004
    s_lshl_b32 s68, s68, 7
    s_mov_b32 s70, 0x55555555
    s_mov_b32 s71, 0x55555555
    v_mov_b32 v5, 0x3f803f80
    v_accvgpr_write_b32 a160, v5
    v_accvgpr_write_b32 a161, v5
    v_accvgpr_write_b32 a162, v5
    v_accvgpr_write_b32 a163, v5
    s_waitcnt vmcnt(6)
    s_add_u32 m0, s29, 81664
    s_nop 0
    buffer_load_dwordx4 v240, s[12:15], s30 offen offset:256 nt lds
    s_add_u32 m0, s29, 82688
    s_nop 0
    buffer_load_dwordx4 v241, s[12:15], s31 offen offset:256 nt lds
    s_mov_b64 exec, 0
    s_cmp_eq_u32 s28, 0
    s_cbranch_scc1 L_pad0
    s_cmp_eq_u32 s28, 1
    s_cbranch_scc1 L_pad1
    s_cmp_eq_u32 s28, 2
    s_cbranch_scc1 L_pad2
    s_branch L_pad3
L_back:
    s_mov_b64 exec, -1
    s_waitcnt vmcnt(6)
    s_barrier
    ds_read_b128 a[96:99], v28 offset:0
    ds_read_b128 a[100:103], v29 offset:0
    ds_read_b128 a[104:107], v28 offset:8192
    ds_read_b128 a[108:111], v29 offset:8192
    ds_read_b128 a[112:115], v28 offset:16384
    ds_read_b128 a[116:119], v29 offset:16384
    ds_read_b128 a[120:123], v28 offset:24576
    ds_read_b128 a[124:127], v29 offset:24576
    s_add_u32 m0, s29, 83584
    s_nop 0
    buffer_load_dwordx4 v240, s[12:15], s30 offen offset:384 nt lds
    s_add_u32 m0, s29, 84608
    s_nop 0
    buffer_load_dwordx4 v241, s[12:15], s31 offen offset:384 nt lds
    s_waitcnt vmcnt(6)
    ds_read_b128 v[160:163], v242 offset:0
    ds_read_b128 v[164:167], v243 offset:0
    s_waitcnt lgkmcnt(1)
    v_lshlrev_b32 v168, 16, v160
    v_and_b32 v169, s3, v160
    v_lshlrev_b32 v170, 16, v161
    v_and_b32 v171, s3, v161
    v_lshlrev_b32 v172, 16, v162
    v_and_b32 v173, s3, v162
    v_lshlrev_b32 v174, 16, v163
    v_and_b32 v175, s3, v163
    v_pk_mul_f32 v[168:169], v[168:169], s[38:39]
    v_pk_mul_f32 v[170:171], v[170:171], s[38:39]
    v_pk_mul_f32 v[172:173], v[172:173], s[38:39]
    v_pk_mul_f32 v[174:175], v[174:175], s[38:39]
    v_cvt_pk_bf16_f32 v168, v168, v169
    v_cvt_pk_bf16_f32 v170, v170, v171
    v_cvt_pk_bf16_f32 v172, v172, v173
    v_cvt_pk_bf16_f32 v174, v174, v175
    v_accvgpr_write_b32 a0, v168
    v_accvgpr_write_b32 a1, v170
    v_accvgpr_write_b32 a2, v172
    v_accvgpr_write_b32 a3, v174
    s_waitcnt lgkmcnt(0)
    v_lshlrev_b32 v176, 16, v164
    v_and_b32 v177, s3, v164
    v_lshlrev_b32 v178, 16, v165
    v_and_b32 v179, s3, v165
    v_lshlrev_b32 v180, 16, v166
    v_and_b32 v181, s3, v166
    v_lshlrev_b32 v182, 16, v167
    v_and_b32 v183, s3, v167
    v_pk_mul_f32 v[176:177], v[176:177], s[38:39]
    v_pk_mul_f32 v[178:179], v[178:179], s[38:39]
    v_pk_mul_f32 v[180:181], v[180:181], s[38:39]
    v_pk_mul_f32 v[182:183], v[182:183], s[38:39]
    v_cvt_pk_bf16_f32 v176, v176, v177
    v_cvt_pk_bf16_f32 v178, v178, v179
    v_cvt_pk_bf16_f32 v180, v180, v181
    v_cvt_pk_bf16_f32 v182, v182, v183
    v_accvgpr_write_b32 a4, v176
    v_accvgpr_write_b32 a5, v178
    v_accvgpr_write_b32 a6, v180
    v_accvgpr_write_b32 a7, v182
    s_nop 0
    v_mfma_f32_16x16x32_bf16 v[64:67], a[96:99], a[0:3], 0
    ds_read_b128 a[164:167], v30 offset:0
    v_mfma_f32_16x16x32_bf16 v[64:67], a[100:103], a[4:7], v[64:67]
    ds_read_b128 a[168:171], v31 offset:0
    v_mfma_f32_16x16x32_bf16 v[208:211], a[104:107], a[0:3], 0
    ds_read_b128 a[172:175], v30 offset:8192
    v_mfma_f32_16x16x32_bf16 v[208:211], a[108:111], a[4:7], v[208:211]
    ds_read_b128 a[176:179], v31 offset:8192
    v_mfma_f32_16x16x32_bf16 v[68:71], a[112:115], a[0:3], 0
    ds_read_b128 a[180:183], v30 offset:16384
    v_mfma_f32_16x16x32_bf16 v[68:71], a[116:119], a[4:7], v[68:71]
    ds_read_b128 a[184:187], v31 offset:16384
    v_mfma_f32_16x16x32_bf16 v[188:191], a[120:123], a[0:3], 0
    ds_read_b128 a[188:191], v30 offset:24576
    v_mfma_f32_16x16x32_bf16 v[188:191], a[124:127], a[4:7], v[188:191]
    ds_read_b128 a[192:195], v31 offset:24576
    s_waitcnt vmcnt(4)
    ds_read_b128 v[160:163], v242 offset:2048
    ds_read_b128 v[164:167], v243 offset:2048
    s_add_u32 m0, s29, 98304
    s_nop 0
    buffer_load_dwordx4 v240, s[12:15], s32 offen offset:0 nt lds
    s_add_u32 m0, s29, 99328
    s_nop 0
    buffer_load_dwordx4 v241, s[12:15], s33 offen offset:0 nt lds
    s_waitcnt lgkmcnt(1)
    v_lshlrev_b32 v168, 16, v160
    v_and_b32 v169, s3, v160
    v_lshlrev_b32 v170, 16, v161
    v_and_b32 v171, s3, v161
    v_lshlrev_b32 v172, 16, v162
    v_and_b32 v173, s3, v162
    v_lshlrev_b32 v174, 16, v163
    v_and_b32 v175, s3, v163
    v_pk_mul_f32 v[168:169], v[168:169], s[38:39]
    v_pk_mul_f32 v[170:171], v[170:171], s[38:39]
    v_pk_mul_f32 v[172:173], v[172:173], s[38:39]
    v_pk_mul_f32 v[174:175], v[174:175], s[38:39]
    v_cvt_pk_bf16_f32 v168, v168, v169
    v_cvt_pk_bf16_f32 v170, v170, v171
    v_cvt_pk_bf16_f32 v172, v172, v173
    v_cvt_pk_bf16_f32 v174, v174, v175
    v_accvgpr_write_b32 a8, v168
    v_accvgpr_write_b32 a9, v170
    v_accvgpr_write_b32 a10, v172
    v_accvgpr_write_b32 a11, v174
    s_waitcnt lgkmcnt(0)
    v_lshlrev_b32 v176, 16, v164
    v_and_b32 v177, s3, v164
    v_lshlrev_b32 v178, 16, v165
    v_and_b32 v179, s3, v165
    v_lshlrev_b32 v180, 16, v166
    v_and_b32 v181, s3, v166
    v_lshlrev_b32 v182, 16, v167
    v_and_b32 v183, s3, v167
    v_pk_mul_f32 v[176:177], v[176:177], s[38:39]
    v_pk_mul_f32 v[178:179], v[178:179], s[38:39]
    v_pk_mul_f32 v[180:181], v[180:181], s[38:39]
    v_pk_mul_f32 v[182:183], v[182:183], s[38:39]
    v_cvt_pk_bf16_f32 v176, v176, v177
    v_cvt_pk_bf16_f32 v178, v178, v179
    v_cvt_pk_bf16_f32 v180, v180, v181
    v_cvt_pk_bf16_f32 v182, v182, v183
    v_accvgpr_write_b32 a12, v176
    v_accvgpr_write_b32 a13, v178
    v_accvgpr_write_b32 a14, v180
    v_accvgpr_write_b32 a15, v182
    s_nop 0
    v_mfma_f32_16x16x32_bf16 v[64:67], a[164:167], a[8:11], v[64:67]
    ds_read_b128 a[96:99], v28 offset:256
    v_mfma_f32_16x16x32_bf16 v[64:67], a[168:171], a[12:15], v[64:67]
    ds_read_b128 a[100:103], v29 offset:256
    v_mfma_f32_16x16x32_bf16 v[208:211], a[172:175], a[8:11], v[208:211]
    ds_read_b128 a[104:107], v28 offset:8448
    v_mfma_f32_16x16x32_bf16 v[208:211], a[176:179], a[12:15], v[208:211]
    ds_read_b128 a[108:111], v29 offset:8448
    v_mfma_f32_16x16x32_bf16 v[68:71], a[180:183], a[8:11], v[68:71]
    ds_read_b128 a[112:115], v28 offset:16640
    v_mfma_f32_16x16x32_bf16 v[68:71], a[184:187], a[12:15], v[68:71]
    ds_read_b128 a[116:119], v29 offset:16640
    v_mfma_f32_16x16x32_bf16 v[188:191], a[188:191], a[8:11], v[188:191]
    ds_read_b128 a[120:123], v28 offset:24832
    v_mfma_f32_16x16x32_bf16 v[188:191], a[192:195], a[12:15], v[188:191]
    ds_read_b128 a[124:127], v29 offset:24832
    s_waitcnt vmcnt(4)
    ds_read_b128 v[160:163], v242 offset:16384
    ds_read_b128 v[164:167], v243 offset:16384
    s_add_u32 m0, s29, 100224
    s_nop 0
    buffer_load_dwordx4 v240, s[12:15], s32 offen offset:128 nt lds
    s_add_u32 m0, s29, 101248
    s_nop 0
    buffer_load_dwordx4 v241, s[12:15], s33 offen offset:128 nt lds
    s_waitcnt lgkmcnt(1)
    v_lshlrev_b32 v168, 16, v160
    v_and_b32 v169, s3, v160
    v_lshlrev_b32 v170, 16, v161
    v_and_b32 v171, s3, v161
    v_lshlrev_b32 v172, 16, v162
    v_and_b32 v173, s3, v162
    v_lshlrev_b32 v174, 16, v163
    v_and_b32 v175, s3, v163
    v_pk_mul_f32 v[168:169], v[168:169], s[38:39]
    v_pk_mul_f32 v[170:171], v[170:171], s[38:39]
    v_pk_mul_f32 v[172:173], v[172:173], s[38:39]
    v_pk_mul_f32 v[174:175], v[174:175], s[38:39]
    v_cvt_pk_bf16_f32 v168, v168, v169
    v_cvt_pk_bf16_f32 v170, v170, v171
    v_cvt_pk_bf16_f32 v172, v172, v173
    v_cvt_pk_bf16_f32 v174, v174, v175
    v_accvgpr_write_b32 a16, v168
    v_accvgpr_write_b32 a17, v170
    v_accvgpr_write_b32 a18, v172
    v_accvgpr_write_b32 a19, v174
    s_waitcnt lgkmcnt(0)
    v_lshlrev_b32 v176, 16, v164
    v_and_b32 v177, s3, v164
    v_lshlrev_b32 v178, 16, v165
    v_and_b32 v179, s3, v165
    v_lshlrev_b32 v180, 16, v166
    v_and_b32 v181, s3, v166
    v_lshlrev_b32 v182, 16, v167
    v_and_b32 v183, s3, v167
    v_pk_mul_f32 v[176:177], v[176:177], s[38:39]
    v_pk_mul_f32 v[178:179], v[178:179], s[38:39]
    v_pk_mul_f32 v[180:181], v[180:181], s[38:39]
    v_pk_mul_f32 v[182:183], v[182:183], s[38:39]
    v_cvt_pk_bf16_f32 v176, v176, v177
    v_cvt_pk_bf16_f32 v178, v178, v179
    v_cvt_pk_bf16_f32 v180, v180, v181
    v_cvt_pk_bf16_f32 v182, v182, v183
    v_accvgpr_write_b32 a20, v176
    v_accvgpr_write_b32 a21, v178
    v_accvgpr_write_b32 a22, v180
    v_accvgpr_write_b32 a23, v182
    s_nop 0
    v_mfma_f32_16x16x32_bf16 v[64:67], a[96:99], a[16:19], v[64:67]
    ds_read_b128 a[164:167], v30 offset:256
    v_mfma_f32_16x16x32_bf16 v[64:67], a[100:103], a[20:23], v[64:67]
    ds_read_b128 a[168:171], v31 offset:256
    v_mfma_f32_16x16x32_bf16 v[208:211], a[104:107], a[16:19], v[208:211]
    ds_read_b128 a[172:175], v30 offset:8448
    v_mfma_f32_16x16x32_bf16 v[208:211], a[108:111], a[20:23], v[208:211]
    ds_read_b128 a[176:179], v31 offset:8448
    v_mfma_f32_16x16x32_bf16 v[68:71], a[112:115], a[16:19], v[68:71]
    ds_read_b128 a[180:183], v30 offset:16640
    v_mfma_f32_16x16x32_bf16 v[68:71], a[116:119], a[20:23], v[68:71]
    ds_read_b128 a[184:187], v31 offset:16640
    v_mfma_f32_16x16x32_bf16 v[188:191], a[120:123], a[16:19], v[188:191]
    ds_read_b128 a[188:191], v30 offset:24832
    v_mfma_f32_16x16x32_bf16 v[188:191], a[124:127], a[20:23], v[188:191]
    ds_read_b128 a[192:195], v31 offset:24832
    s_waitcnt vmcnt(4)
    ds_read_b128 v[160:163], v242 offset:18432
    ds_read_b128 v[164:167], v243 offset:18432
    s_add_u32 m0, s29, 114432
    s_nop 0
    buffer_load_dwordx4 v240, s[12:15], s32 offen offset:256 nt lds
    s_add_u32 m0, s29, 115456
    s_nop 0
    buffer_load_dwordx4 v241, s[12:15], s33 offen offset:256 nt lds
    s_waitcnt lgkmcnt(1)
    v_lshlrev_b32 v168, 16, v160
    v_and_b32 v169, s3, v160
    v_lshlrev_b32 v170, 16, v161
    v_and_b32 v171, s3, v161
    v_lshlrev_b32 v172, 16, v162
    v_and_b32 v173, s3, v162
    v_lshlrev_b32 v174, 16, v163
    v_and_b32 v175, s3, v163
    v_pk_mul_f32 v[168:169], v[168:169], s[38:39]
    v_pk_mul_f32 v[170:171], v[170:171], s[38:39]
    v_pk_mul_f32 v[172:173], v[172:173], s[38:39]
    v_pk_mul_f32 v[174:175], v[174:175], s[38:39]
    v_cvt_pk_bf16_f32 v168, v168, v169
    v_cvt_pk_bf16_f32 v170, v170, v171
    v_cvt_pk_bf16_f32 v172, v172, v173
    v_cvt_pk_bf16_f32 v174, v174, v175
    v_accvgpr_write_b32 a24, v168
    v_accvgpr_write_b32 a25, v170
    v_accvgpr_write_b32 a26, v172
    v_accvgpr_write_b32 a27, v174
    s_waitcnt lgkmcnt(0)
    v_lshlrev_b32 v176, 16, v164
    v_and_b32 v177, s3, v164
    v_lshlrev_b32 v178, 16, v165
    v_and_b32 v179, s3, v165
    v_lshlrev_b32 v180, 16, v166
    v_and_b32 v181, s3, v166
    v_lshlrev_b32 v182, 16, v167
    v_and_b32 v183, s3, v167
    v_pk_mul_f32 v[176:177], v[176:177], s[38:39]
    v_pk_mul_f32 v[178:179], v[178:179], s[38:39]
    v_pk_mul_f32 v[180:181], v[180:181], s[38:39]
    v_pk_mul_f32 v[182:183], v[182:183], s[38:39]
    v_cvt_pk_bf16_f32 v176, v176, v177
    v_cvt_pk_bf16_f32 v178, v178, v179
    v_cvt_pk_bf16_f32 v180, v180, v181
    v_cvt_pk_bf16_f32 v182, v182, v183
    v_accvgpr_write_b32 a28, v176
    v_accvgpr_write_b32 a29, v178
    v_accvgpr_write_b32 a30, v180
    v_accvgpr_write_b32 a31, v182
    s_nop 0
    v_mfma_f32_16x16x32_bf16 v[64:67], a[164:167], a[24:27], v[64:67]
    ds_read_b128 a[96:99], v28 offset:0
    v_mfma_f32_16x16x32_bf16 v[64:67], a[168:171], a[28:31], v[64:67]
    ds_read_b128 a[100:103], v29 offset:0
    v_mfma_f32_16x16x32_bf16 v[208:211], a[172:175], a[24:27], v[208:211]
    ds_read_b128 a[104:107], v28 offset:8192
    v_mfma_f32_16x16x32_bf16 v[208:211], a[176:179], a[28:31], v[208:211]
    ds_read_b128 a[108:111], v29 offset:8192
    v_mfma_f32_16x16x32_bf16 v[68:71], a[180:183], a[24:27], v[68:71]
    ds_read_b128 a[112:115], v28 offset:16384
    v_mfma_f32_16x16x32_bf16 v[68:71], a[184:187], a[28:31], v[68:71]
    ds_read_b128 a[116:119], v29 offset:16384
    v_mfma_f32_16x16x32_bf16 v[188:191], a[188:191], a[24:27], v[188:191]
    ds_read_b128 a[120:123], v28 offset:24576
    v_mfma_f32_16x16x32_bf16 v[188:191], a[192:195], a[28:31], v[188:191]
    ds_read_b128 a[124:127], v29 offset:24576
    s_waitcnt vmcnt(4)
    ds_read_b128 v[160:163], v242 offset:32768
    ds_read_b128 v[164:167], v243 offset:32768
    s_add_u32 m0, s29, 116352
    s_nop 0
    buffer_load_dwordx4 v240, s[12:15], s32 offen offset:384 nt lds
    s_add_u32 m0, s29, 117376
    s_nop 0
    buffer_load_dwordx4 v241, s[12:15], s33 offen offset:384 nt lds
    v_max3_f32 v244, v64, v65, v66
    v_max3_f32 v244, v244, v67, v252
    v_mov_b32 v236, v244
    s_nop 1
    v_permlane32_swap_b32 v244, v236
    v_max_f32 v244, v244, v236
    v_mov_b32 v236, v244
    s_nop 1
    v_permlane16_swap_b32 v244, v236
    v_max_f32 v244, v244, v236
    v_sub_f32 v16, 0, v244
    v_sub_f32 v17, 0, v244
    v_sub_f32 v18, 0, v244
    v_sub_f32 v19, 0, v244
    s_waitcnt lgkmcnt(1)
    v_lshlrev_b32 v168, 16, v160
    v_and_b32 v169, s3, v160
    v_lshlrev_b32 v170, 16, v161
    v_and_b32 v171, s3, v161
    v_lshlrev_b32 v172, 16, v162
    v_and_b32 v173, s3, v162
    v_lshlrev_b32 v174, 16, v163
    v_and_b32 v175, s3, v163
    v_pk_mul_f32 v[168:169], v[168:169], s[38:39]
    v_pk_mul_f32 v[170:171], v[170:171], s[38:39]
    v_pk_mul_f32 v[172:173], v[172:173], s[38:39]
    v_pk_mul_f32 v[174:175], v[174:175], s[38:39]
    v_cvt_pk_bf16_f32 v168, v168, v169
    v_cvt_pk_bf16_f32 v170, v170, v171
    v_cvt_pk_bf16_f32 v172, v172, v173
    v_cvt_pk_bf16_f32 v174, v174, v175
    v_accvgpr_write_b32 a32, v168
    v_accvgpr_write_b32 a33, v170
    v_accvgpr_write_b32 a34, v172
    v_accvgpr_write_b32 a35, v174
    s_waitcnt lgkmcnt(0)
    v_lshlrev_b32 v176, 16, v164
    v_and_b32 v177, s3, v164
    v_lshlrev_b32 v178, 16, v165
    v_and_b32 v179, s3, v165
    v_lshlrev_b32 v180, 16, v166
    v_and_b32 v181, s3, v166
    v_lshlrev_b32 v182, 16, v167
    v_and_b32 v183, s3, v167
    v_pk_mul_f32 v[176:177], v[176:177], s[38:39]
    v_pk_mul_f32 v[178:179], v[178:179], s[38:39]
    v_pk_mul_f32 v[180:181], v[180:181], s[38:39]
    v_pk_mul_f32 v[182:183], v[182:183], s[38:39]
    v_cvt_pk_bf16_f32 v176, v176, v177
    v_cvt_pk_bf16_f32 v178, v178, v179
    v_cvt_pk_bf16_f32 v180, v180, v181
    v_cvt_pk_bf16_f32 v182, v182, v183
    v_accvgpr_write_b32 a36, v176
    v_accvgpr_write_b32 a37, v178
    v_accvgpr_write_b32 a38, v180
    v_accvgpr_write_b32 a39, v182
    s_nop 0
    v_mfma_f32_16x16x32_bf16 v[72:75], a[96:99], a[32:35], 0
    ds_read_b128 a[164:167], v30 offset:0
    v_sub_f32 v64, v64, v244
    v_mfma_f32_16x16x32_bf16 v[72:75], a[100:103], a[36:39], v[72:75]
    ds_read_b128 a[168:171], v31 offset:0
    v_sub_f32 v65, v65, v244
    v_mfma_f32_16x16x32_bf16 v[216:219], a[104:107], a[32:35], 0
    ds_read_b128 a[172:175], v30 offset:8192
    v_sub_f32 v66, v66, v244
    v_mfma_f32_16x16x32_bf16 v[216:219], a[108:111], a[36:39], v[216:219]
    ds_read_b128 a[176:179], v31 offset:8192
    v_sub_f32 v67, v67, v244
    v_mfma_f32_16x16x32_bf16 v[76:79], a[112:115], a[32:35], 0
    ds_read_b128 a[180:183], v30 offset:16384
    v_sub_f32 v208, v208, v244
    v_mfma_f32_16x16x32_bf16 v[76:79], a[116:119], a[36:39], v[76:79]
    ds_read_b128 a[184:187], v31 offset:16384
    v_sub_f32 v209, v209, v244
    v_mfma_f32_16x16x32_bf16 v[196:199], a[120:123], a[32:35], 0
    ds_read_b128 a[188:191], v30 offset:24576
    v_sub_f32 v210, v210, v244
    v_mfma_f32_16x16x32_bf16 v[196:199], a[124:127], a[36:39], v[196:199]
    ds_read_b128 a[192:195], v31 offset:24576
    v_sub_f32 v211, v211, v244
    s_waitcnt vmcnt(4)
    ds_read_b128 v[160:163], v242 offset:34816
    ds_read_b128 v[164:167], v243 offset:34816
    s_add_u32 m0, s29, 131072
    s_nop 0
    buffer_load_dwordx4 v240, s[12:15], s34 offen offset:0 nt lds
    s_add_u32 m0, s29, 132096
    s_nop 0
    buffer_load_dwordx4 v241, s[12:15], s35 offen offset:0 nt lds
    v_exp_f32 v64, v64
    v_exp_f32 v65, v65
    v_exp_f32 v66, v66
    v_exp_f32 v67, v67
    v_exp_f32 v208, v208
    v_exp_f32 v209, v209
    v_exp_f32 v210, v210
    v_exp_f32 v211, v211
    s_waitcnt lgkmcnt(1)
    v_lshlrev_b32 v168, 16, v160
    v_and_b32 v169, s3, v160
    v_lshlrev_b32 v170, 16, v161
    v_and_b32 v171, s3, v161
    v_lshlrev_b32 v172, 16, v162
    v_and_b32 v173, s3, v162
    v_lshlrev_b32 v174, 16, v163
    v_and_b32 v175, s3, v163
    v_pk_mul_f32 v[168:169], v[168:169], s[38:39]
    v_pk_mul_f32 v[170:171], v[170:171], s[38:39]
    v_pk_mul_f32 v[172:173], v[172:173], s[38:39]
    v_pk_mul_f32 v[174:175], v[174:175], s[38:39]
    v_cvt_pk_bf16_f32 v168, v168, v169
    v_cvt_pk_bf16_f32 v170, v170, v171
    v_cvt_pk_bf16_f32 v172, v172, v173
    v_cvt_pk_bf16_f32 v174, v174, v175
    v_accvgpr_write_b32 a40, v168
    v_accvgpr_write_b32 a41, v170
    v_accvgpr_write_b32 a42, v172
    v_accvgpr_write_b32 a43, v174
    s_waitcnt lgkmcnt(0)
    v_lshlrev_b32 v176, 16, v164
    v_and_b32 v177, s3, v164
    v_lshlrev_b32 v178, 16, v165
    v_and_b32 v179, s3, v165
    v_lshlrev_b32 v180, 16, v166
    v_and_b32 v181, s3, v166
    v_lshlrev_b32 v182, 16, v167
    v_and_b32 v183, s3, v167
    v_pk_mul_f32 v[176:177], v[176:177], s[38:39]
    v_pk_mul_f32 v[178:179], v[178:179], s[38:39]
    v_pk_mul_f32 v[180:181], v[180:181], s[38:39]
    v_pk_mul_f32 v[182:183], v[182:183], s[38:39]
    v_cvt_pk_bf16_f32 v176, v176, v177
    v_cvt_pk_bf16_f32 v178, v178, v179
    v_cvt_pk_bf16_f32 v180, v180, v181
    v_cvt_pk_bf16_f32 v182, v182, v183
    v_accvgpr_write_b32 a44, v176
    v_accvgpr_write_b32 a45, v178
    v_accvgpr_write_b32 a46, v180
    v_accvgpr_write_b32 a47, v182
    s_nop 0
    v_mfma_f32_16x16x32_bf16 v[72:75], a[164:167], a[40:43], v[72:75]
    ds_read_b128 a[96:99], v28 offset:256
    v_sub_f32 v68, v68, v244
    v_mfma_f32_16x16x32_bf16 v[72:75], a[168:171], a[44:47], v[72:75]
    ds_read_b128 a[100:103], v29 offset:256
    v_sub_f32 v69, v69, v244
    v_mfma_f32_16x16x32_bf16 v[216:219], a[172:175], a[40:43], v[216:219]
    ds_read_b128 a[104:107], v28 offset:8448
    v_sub_f32 v70, v70, v244
    v_mfma_f32_16x16x32_bf16 v[216:219], a[176:179], a[44:47], v[216:219]
    ds_read_b128 a[108:111], v29 offset:8448
    v_sub_f32 v71, v71, v244
    v_mfma_f32_16x16x32_bf16 v[76:79], a[180:183], a[40:43], v[76:79]
    ds_read_b128 a[112:115], v28 offset:16640
    v_sub_f32 v188, v188, v244
    v_mfma_f32_16x16x32_bf16 v[76:79], a[184:187], a[44:47], v[76:79]
    ds_read_b128 a[116:119], v29 offset:16640
    v_sub_f32 v189, v189, v244
    v_mfma_f32_16x16x32_bf16 v[196:199], a[188:191], a[40:43], v[196:199]
    ds_read_b128 a[120:123], v28 offset:24832
    v_sub_f32 v190, v190, v244
    v_mfma_f32_16x16x32_bf16 v[196:199], a[192:195], a[44:47], v[196:199]
    ds_read_b128 a[124:127], v29 offset:24832
    v_sub_f32 v191, v191, v244
    s_waitcnt vmcnt(4)
    ds_read_b128 v[160:163], v242 offset:49152
    ds_read_b128 v[164:167], v243 offset:49152
    s_add_u32 m0, s29, 132992
    s_nop 0
    buffer_load_dwordx4 v240, s[12:15], s34 offen offset:128 nt lds
    s_add_u32 m0, s29, 134016
    s_nop 0
    buffer_load_dwordx4 v241, s[12:15], s35 offen offset:128 nt lds
    v_exp_f32 v68, v68
    v_exp_f32 v69, v69
    v_exp_f32 v70, v70
    v_exp_f32 v71, v71
    v_exp_f32 v188, v188
    v_exp_f32 v189, v189
    v_exp_f32 v190, v190
    v_exp_f32 v191, v191
    s_waitcnt lgkmcnt(1)
    v_lshlrev_b32 v168, 16, v160
    v_and_b32 v169, s3, v160
    v_lshlrev_b32 v170, 16, v161
    v_and_b32 v171, s3, v161
    v_lshlrev_b32 v172, 16, v162
    v_and_b32 v173, s3, v162
    v_lshlrev_b32 v174, 16, v163
    v_and_b32 v175, s3, v163
    v_pk_mul_f32 v[168:169], v[168:169], s[38:39]
    v_pk_mul_f32 v[170:171], v[170:171], s[38:39]
    v_pk_mul_f32 v[172:173], v[172:173], s[38:39]
    v_pk_mul_f32 v[174:175], v[174:175], s[38:39]
    v_cvt_pk_bf16_f32 v168, v168, v169
    v_cvt_pk_bf16_f32 v170, v170, v171
    v_cvt_pk_bf16_f32 v172, v172, v173
    v_cvt_pk_bf16_f32 v174, v174, v175
    v_accvgpr_write_b32 a48, v168
    v_accvgpr_write_b32 a49, v170
    v_accvgpr_write_b32 a50, v172
    v_accvgpr_write_b32 a51, v174
    s_waitcnt lgkmcnt(0)
    v_lshlrev_b32 v176, 16, v164
    v_and_b32 v177, s3, v164
    v_lshlrev_b32 v178, 16, v165
    v_and_b32 v179, s3, v165
    v_lshlrev_b32 v180, 16, v166
    v_and_b32 v181, s3, v166
    v_lshlrev_b32 v182, 16, v167
    v_and_b32 v183, s3, v167
    v_pk_mul_f32 v[176:177], v[176:177], s[38:39]
    v_pk_mul_f32 v[178:179], v[178:179], s[38:39]
    v_pk_mul_f32 v[180:181], v[180:181], s[38:39]
    v_pk_mul_f32 v[182:183], v[182:183], s[38:39]
    v_cvt_pk_bf16_f32 v176, v176, v177
    v_cvt_pk_bf16_f32 v178, v178, v179
    v_cvt_pk_bf16_f32 v180, v180, v181
    v_cvt_pk_bf16_f32 v182, v182, v183
    v_accvgpr_write_b32 a52, v176
    v_accvgpr_write_b32 a53, v178
    v_accvgpr_write_b32 a54, v180
    v_accvgpr_write_b32 a55, v182
    s_nop 0
    v_mfma_f32_16x16x32_bf16 v[72:75], a[96:99], a[48:51], v[72:75]
    ds_read_b128 a[164:167], v30 offset:256
    v_cvt_pk_bf16_f32 v64, v64, v65
    v_mfma_f32_16x16x32_bf16 v[72:75], a[100:103], a[52:55], v[72:75]
    ds_read_b128 a[168:171], v31 offset:256
    v_cvt_pk_bf16_f32 v65, v66, v67
    v_mfma_f32_16x16x32_bf16 v[216:219], a[104:107], a[48:51], v[216:219]
    ds_read_b128 a[172:175], v30 offset:8448
    v_cvt_pk_bf16_f32 v66, v208, v209
    v_mfma_f32_16x16x32_bf16 v[216:219], a[108:111], a[52:55], v[216:219]
    ds_read_b128 a[176:179], v31 offset:8448
    v_cvt_pk_bf16_f32 v67, v210, v211
    v_mfma_f32_16x16x32_bf16 v[76:79], a[112:115], a[48:51], v[76:79]
    ds_read_b128 a[180:183], v30 offset:16640
    v_cvt_pk_bf16_f32 v68, v68, v69
    v_mfma_f32_16x16x32_bf16 v[76:79], a[116:119], a[52:55], v[76:79]
    ds_read_b128 a[184:187], v31 offset:16640
    v_cvt_pk_bf16_f32 v69, v70, v71
    v_mfma_f32_16x16x32_bf16 v[196:199], a[120:123], a[48:51], v[196:199]
    ds_read_b128 a[188:191], v30 offset:24832
    v_cvt_pk_bf16_f32 v70, v188, v189
    v_mfma_f32_16x16x32_bf16 v[196:199], a[124:127], a[52:55], v[196:199]
    ds_read_b128 a[192:195], v31 offset:24832
    v_cvt_pk_bf16_f32 v71, v190, v191
    s_waitcnt vmcnt(4)
    ds_read_b128 v[160:163], v242 offset:51200
    ds_read_b128 v[164:167], v243 offset:51200
    s_add_u32 m0, s29, 147200
    s_nop 0
    buffer_load_dwordx4 v240, s[12:15], s34 offen offset:256 nt lds
    s_add_u32 m0, s29, 148224
    s_nop 0
    buffer_load_dwordx4 v241, s[12:15], s35 offen offset:256 nt lds
    s_waitcnt lgkmcnt(1)
    v_lshlrev_b32 v168, 16, v160
    v_and_b32 v169, s3, v160
    v_lshlrev_b32 v170, 16, v161
    v_and_b32 v171, s3, v161
    v_lshlrev_b32 v172, 16, v162
    v_and_b32 v173, s3, v162
    v_lshlrev_b32 v174, 16, v163
    v_and_b32 v175, s3, v163
    v_pk_mul_f32 v[168:169], v[168:169], s[38:39]
    v_pk_mul_f32 v[170:171], v[170:171], s[38:39]
    v_pk_mul_f32 v[172:173], v[172:173], s[38:39]
    v_pk_mul_f32 v[174:175], v[174:175], s[38:39]
    v_cvt_pk_bf16_f32 v168, v168, v169
    v_cvt_pk_bf16_f32 v170, v170, v171
    v_cvt_pk_bf16_f32 v172, v172, v173
    v_cvt_pk_bf16_f32 v174, v174, v175
    v_accvgpr_write_b32 a56, v168
    v_accvgpr_write_b32 a57, v170
    v_accvgpr_write_b32 a58, v172
    v_accvgpr_write_b32 a59, v174
    s_waitcnt lgkmcnt(0)
    v_lshlrev_b32 v176, 16, v164
    v_and_b32 v177, s3, v164
    v_lshlrev_b32 v178, 16, v165
    v_and_b32 v179, s3, v165
    v_lshlrev_b32 v180, 16, v166
    v_and_b32 v181, s3, v166
    v_lshlrev_b32 v182, 16, v167
    v_and_b32 v183, s3, v167
    v_pk_mul_f32 v[176:177], v[176:177], s[38:39]
    v_pk_mul_f32 v[178:179], v[178:179], s[38:39]
L_pad0:
    s_cbranch_execz L_pad4
    v_pk_mul_f32 v[180:181], v[180:181], s[38:39]
    v_pk_mul_f32 v[182:183], v[182:183], s[38:39]
    v_cvt_pk_bf16_f32 v176, v176, v177
    v_cvt_pk_bf16_f32 v178, v178, v179
    v_cvt_pk_bf16_f32 v180, v180, v181
    v_cvt_pk_bf16_f32 v182, v182, v183
    v_accvgpr_write_b32 a60, v176
    v_accvgpr_write_b32 a61, v178
    v_accvgpr_write_b32 a62, v180
    v_accvgpr_write_b32 a63, v182
    s_nop 0
    v_mfma_f32_16x16x32_bf16 v[72:75], a[164:167], a[56:59], v[72:75]
    ds_read_b128 a[96:99], v28 offset:0
    v_mfma_f32_16x16x32_bf16 v[72:75], a[168:171], a[60:63], v[72:75]
    ds_read_b128 a[100:103], v29 offset:0
    v_mfma_f32_16x16x32_bf16 v[216:219], a[172:175], a[56:59], v[216:219]
    ds_read_b128 a[104:107], v28 offset:8192
    v_mfma_f32_16x16x32_bf16 v[216:219], a[176:179], a[60:63], v[216:219]
    ds_read_b128 a[108:111], v29 offset:8192
    v_mfma_f32_16x16x32_bf16 v[76:79], a[180:183], a[56:59], v[76:79]
    ds_read_b128 a[112:115], v28 offset:16384
    v_mfma_f32_16x16x32_bf16 v[76:79], a[184:187], a[60:63], v[76:79]
    ds_read_b128 a[116:119], v29 offset:16384
    v_mfma_f32_16x16x32_bf16 v[196:199], a[188:191], a[56:59], v[196:199]
    ds_read_b128 a[120:123], v28 offset:24576
    v_mfma_f32_16x16x32_bf16 v[196:199], a[192:195], a[60:63], v[196:199]
    ds_read_b128 a[124:127], v29 offset:24576
    s_waitcnt vmcnt(4)
    v_add_u32 v242, 0x10000, v242
    v_add_u32 v243, 0x10000, v243
    ds_read_b128 v[160:163], v242 offset:0
    ds_read_b128 v[164:167], v243 offset:0
    s_add_u32 m0, s29, 149120
    s_nop 0
    buffer_load_dwordx4 v240, s[12:15], s34 offen offset:384 nt lds
    s_add_u32 m0, s29, 150144
    s_nop 0
    buffer_load_dwordx4 v241, s[12:15], s35 offen offset:384 nt lds
    v_max3_f32 v245, v72, v73, v74
    v_max3_f32 v245, v245, v75, v253
    v_mov_b32 v237, v245
    s_nop 1
    v_permlane32_swap_b32 v245, v237
    v_max_f32 v245, v245, v237
    v_mov_b32 v237, v245
    s_nop 1
    v_permlane16_swap_b32 v245, v237
    v_max_f32 v245, v245, v237
    v_sub_f32 v20, 0, v245
    v_sub_f32 v21, 0, v245
    v_sub_f32 v22, 0, v245
    v_sub_f32 v23, 0, v245
    s_waitcnt lgkmcnt(1)
    v_lshlrev_b32 v168, 16, v160
    v_and_b32 v169, s3, v160
    v_lshlrev_b32 v170, 16, v161
    v_and_b32 v171, s3, v161
    v_lshlrev_b32 v172, 16, v162
    v_and_b32 v173, s3, v162
    v_lshlrev_b32 v174, 16, v163
    v_and_b32 v175, s3, v163
    v_pk_mul_f32 v[168:169], v[168:169], s[38:39]
    v_pk_mul_f32 v[170:171], v[170:171], s[38:39]
    v_pk_mul_f32 v[172:173], v[172:173], s[38:39]
    v_pk_mul_f32 v[174:175], v[174:175], s[38:39]
    v_cvt_pk_bf16_f32 v168, v168, v169
    v_cvt_pk_bf16_f32 v170, v170, v171
    v_cvt_pk_bf16_f32 v172, v172, v173
    v_cvt_pk_bf16_f32 v174, v174, v175
    v_accvgpr_write_b32 a64, v168
    v_accvgpr_write_b32 a65, v170
    v_accvgpr_write_b32 a66, v172
    v_accvgpr_write_b32 a67, v174
    s_waitcnt lgkmcnt(0)
    v_lshlrev_b32 v176, 16, v164
    v_and_b32 v177, s3, v164
    v_lshlrev_b32 v178, 16, v165
    v_and_b32 v179, s3, v165
    v_lshlrev_b32 v180, 16, v166
    v_and_b32 v181, s3, v166
    v_lshlrev_b32 v182, 16, v167
    v_and_b32 v183, s3, v167
    v_pk_mul_f32 v[176:177], v[176:177], s[38:39]
    v_pk_mul_f32 v[178:179], v[178:179], s[38:39]
    v_pk_mul_f32 v[180:181], v[180:181], s[38:39]
    v_pk_mul_f32 v[182:183], v[182:183], s[38:39]
    v_cvt_pk_bf16_f32 v176, v176, v177
    v_cvt_pk_bf16_f32 v178, v178, v179
    v_cvt_pk_bf16_f32 v180, v180, v181
    v_cvt_pk_bf16_f32 v182, v182, v183
    v_accvgpr_write_b32 a68, v176
    v_accvgpr_write_b32 a69, v178
    v_accvgpr_write_b32 a70, v180
    v_accvgpr_write_b32 a71, v182
    s_nop 0
    v_mfma_f32_16x16x32_bf16 v[80:83], a[96:99], a[64:67], 0
    ds_read_b128 a[164:167], v30 offset:0
    v_sub_f32 v72, v72, v245
    v_mfma_f32_16x16x32_bf16 v[80:83], a[100:103], a[68:71], v[80:83]
    ds_read_b128 a[168:171], v31 offset:0
    v_sub_f32 v73, v73, v245
    v_mfma_f32_16x16x32_bf16 v[220:223], a[104:107], a[64:67], 0
    ds_read_b128 a[172:175], v30 offset:8192
    v_sub_f32 v74, v74, v245
    v_mfma_f32_16x16x32_bf16 v[220:223], a[108:111], a[68:71], v[220:223]
    ds_read_b128 a[176:179], v31 offset:8192
    v_sub_f32 v75, v75, v245
    v_mfma_f32_16x16x32_bf16 v[84:87], a[112:115], a[64:67], 0
    ds_read_b128 a[180:183], v30 offset:16384
    v_sub_f32 v216, v216, v245
    v_mfma_f32_16x16x32_bf16 v[84:87], a[116:119], a[68:71], v[84:87]
    ds_read_b128 a[184:187], v31 offset:16384
    v_sub_f32 v217, v217, v245
    v_mfma_f32_16x16x32_bf16 v[228:231], a[120:123], a[64:67], 0
    ds_read_b128 a[188:191], v30 offset:24576
    v_sub_f32 v218, v218, v245
    v_mfma_f32_16x16x32_bf16 v[228:231], a[124:127], a[68:71], v[228:231]
    ds_read_b128 a[192:195], v31 offset:24576
    v_sub_f32 v219, v219, v245
    s_waitcnt vmcnt(4)
    ds_read_b128 v[160:163], v242 offset:2048
    ds_read_b128 v[164:167], v243 offset:2048
    s_add_u32 m0, s29, 32768
    s_mov_b32 s36, 32768
    buffer_load_dwordx4 v52, s[16:19], s36 offen offset:0 nt lds
    buffer_load_dwordx4 v53, s[16:19], s36 offen offset:1024 nt lds
    v_exp_f32 v72, v72
    v_exp_f32 v73, v73
    v_exp_f32 v74, v74
    v_exp_f32 v75, v75
    v_exp_f32 v216, v216
    v_exp_f32 v217, v217
    v_exp_f32 v218, v218
    v_exp_f32 v219, v219
    s_waitcnt lgkmcnt(1)
    v_lshlrev_b32 v168, 16, v160
    v_and_b32 v169, s3, v160
    v_lshlrev_b32 v170, 16, v161
    v_and_b32 v171, s3, v161
    v_lshlrev_b32 v172, 16, v162
    v_and_b32 v173, s3, v162
    v_lshlrev_b32 v174, 16, v163
    v_and_b32 v175, s3, v163
    v_pk_mul_f32 v[168:169], v[168:169], s[38:39]
    v_pk_mul_f32 v[170:171], v[170:171], s[38:39]
    v_pk_mul_f32 v[172:173], v[172:173], s[38:39]
    v_pk_mul_f32 v[174:175], v[174:175], s[38:39]
    v_cvt_pk_bf16_f32 v168, v168, v169
    v_cvt_pk_bf16_f32 v170, v170, v171
    v_cvt_pk_bf16_f32 v172, v172, v173
    v_cvt_pk_bf16_f32 v174, v174, v175
    v_accvgpr_write_b32 a72, v168
    v_accvgpr_write_b32 a73, v170
    v_accvgpr_write_b32 a74, v172
    v_accvgpr_write_b32 a75, v174
    s_waitcnt lgkmcnt(0)
    v_lshlrev_b32 v176, 16, v164
    v_and_b32 v177, s3, v164
    v_lshlrev_b32 v178, 16, v165
    v_and_b32 v179, s3, v165
    v_lshlrev_b32 v180, 16, v166
    v_and_b32 v181, s3, v166
    v_lshlrev_b32 v182, 16, v167
    v_and_b32 v183, s3, v167
    v_pk_mul_f32 v[176:177], v[176:177], s[38:39]
    v_pk_mul_f32 v[178:179], v[178:179], s[38:39]
    v_pk_mul_f32 v[180:181], v[180:181], s[38:39]
    v_pk_mul_f32 v[182:183], v[182:183], s[38:39]
    v_cvt_pk_bf16_f32 v176, v176, v177
    v_cvt_pk_bf16_f32 v178, v178, v179
    v_cvt_pk_bf16_f32 v180, v180, v181
    v_cvt_pk_bf16_f32 v182, v182, v183
    v_accvgpr_write_b32 a76, v176
    v_accvgpr_write_b32 a77, v178
    v_accvgpr_write_b32 a78, v180
    v_accvgpr_write_b32 a79, v182
    s_nop 0
    v_mfma_f32_16x16x32_bf16 v[80:83], a[164:167], a[72:75], v[80:83]
    ds_read_b128 a[96:99], v28 offset:256
    v_sub_f32 v76, v76, v245
    v_mfma_f32_16x16x32_bf16 v[80:83], a[168:171], a[76:79], v[80:83]
    ds_read_b128 a[100:103], v29 offset:256
    v_sub_f32 v77, v77, v245
    v_mfma_f32_16x16x32_bf16 v[220:223], a[172:175], a[72:75], v[220:223]
    ds_read_b128 a[104:107], v28 offset:8448
    v_sub_f32 v78, v78, v245
    v_mfma_f32_16x16x32_bf16 v[220:223], a[176:179], a[76:79], v[220:223]
    ds_read_b128 a[108:111], v29 offset:8448
    v_sub_f32 v79, v79, v245
    v_mfma_f32_16x16x32_bf16 v[84:87], a[180:183], a[72:75], v[84:87]
    ds_read_b128 a[112:115], v28 offset:16640
    v_sub_f32 v196, v196, v245
    v_mfma_f32_16x16x32_bf16 v[84:87], a[184:187], a[76:79], v[84:87]
    ds_read_b128 a[116:119], v29 offset:16640
    v_sub_f32 v197, v197, v245
    v_mfma_f32_16x16x32_bf16 v[228:231], a[188:191], a[72:75], v[228:231]
    ds_read_b128 a[120:123], v28 offset:24832
    v_sub_f32 v198, v198, v245
    v_mfma_f32_16x16x32_bf16 v[228:231], a[192:195], a[76:79], v[228:231]
    ds_read_b128 a[124:127], v29 offset:24832
    v_sub_f32 v199, v199, v245
    s_waitcnt vmcnt(4)
    ds_read_b128 v[160:163], v242 offset:16384
    ds_read_b128 v[164:167], v243 offset:16384
    s_add_u32 m0, s29, 32768
    s_mov_b32 s36, 32768
    buffer_load_dwordx4 v54, s[16:19], s36 offen offset:2048 nt lds
    buffer_load_dwordx4 v55, s[16:19], s36 offen offset:3072 nt lds
    v_exp_f32 v76, v76
    v_exp_f32 v77, v77
    v_exp_f32 v78, v78
    v_exp_f32 v79, v79
    v_exp_f32 v196, v196
    v_exp_f32 v197, v197
    v_exp_f32 v198, v198
    v_exp_f32 v199, v199
    s_waitcnt lgkmcnt(1)
    v_lshlrev_b32 v168, 16, v160
    v_and_b32 v169, s3, v160
    v_lshlrev_b32 v170, 16, v161
    v_and_b32 v171, s3, v161
    v_lshlrev_b32 v172, 16, v162
    v_and_b32 v173, s3, v162
    v_lshlrev_b32 v174, 16, v163
    v_and_b32 v175, s3, v163
    v_pk_mul_f32 v[168:169], v[168:169], s[38:39]
    v_pk_mul_f32 v[170:171], v[170:171], s[38:39]
    v_pk_mul_f32 v[172:173], v[172:173], s[38:39]
    v_pk_mul_f32 v[174:175], v[174:175], s[38:39]
    v_cvt_pk_bf16_f32 v168, v168, v169
    v_cvt_pk_bf16_f32 v170, v170, v171
    v_cvt_pk_bf16_f32 v172, v172, v173
    v_cvt_pk_bf16_f32 v174, v174, v175
    v_accvgpr_write_b32 a80, v168
    v_accvgpr_write_b32 a81, v170
    v_accvgpr_write_b32 a82, v172
    v_accvgpr_write_b32 a83, v174
    s_waitcnt lgkmcnt(0)
    v_lshlrev_b32 v176, 16, v164
    v_and_b32 v177, s3, v164
    v_lshlrev_b32 v178, 16, v165
    v_and_b32 v179, s3, v165
    v_lshlrev_b32 v180, 16, v166
    v_and_b32 v181, s3, v166
    v_lshlrev_b32 v182, 16, v167
    v_and_b32 v183, s3, v167
    v_pk_mul_f32 v[176:177], v[176:177], s[38:39]
    v_pk_mul_f32 v[178:179], v[178:179], s[38:39]
    v_pk_mul_f32 v[180:181], v[180:181], s[38:39]
    v_pk_mul_f32 v[182:183], v[182:183], s[38:39]
    v_cvt_pk_bf16_f32 v176, v176, v177
    v_cvt_pk_bf16_f32 v178, v178, v179
    v_cvt_pk_bf16_f32 v180, v180, v181
    v_cvt_pk_bf16_f32 v182, v182, v183
    v_accvgpr_write_b32 a84, v176
    v_accvgpr_write_b32 a85, v178
    v_accvgpr_write_b32 a86, v180
    v_accvgpr_write_b32 a87, v182
    s_nop 0
    v_mfma_f32_16x16x32_bf16 v[80:83], a[96:99], a[80:83], v[80:83]
    ds_read_b128 a[164:167], v30 offset:256
    v_cvt_pk_bf16_f32 v72, v72, v73
    v_mfma_f32_16x16x32_bf16 v[80:83], a[100:103], a[84:87], v[80:83]
    ds_read_b128 a[168:171], v31 offset:256
    v_cvt_pk_bf16_f32 v73, v74, v75
    v_mfma_f32_16x16x32_bf16 v[220:223], a[104:107], a[80:83], v[220:223]
    ds_read_b128 a[172:175], v30 offset:8448
    v_cvt_pk_bf16_f32 v74, v216, v217
    v_mfma_f32_16x16x32_bf16 v[220:223], a[108:111], a[84:87], v[220:223]
    ds_read_b128 a[176:179], v31 offset:8448
    v_cvt_pk_bf16_f32 v75, v218, v219
    v_mfma_f32_16x16x32_bf16 v[84:87], a[112:115], a[80:83], v[84:87]
    ds_read_b128 a[180:183], v30 offset:16640
    v_cvt_pk_bf16_f32 v76, v76, v77
    v_mfma_f32_16x16x32_bf16 v[84:87], a[116:119], a[84:87], v[84:87]
    ds_read_b128 a[184:187], v31 offset:16640
    v_cvt_pk_bf16_f32 v77, v78, v79
    v_mfma_f32_16x16x32_bf16 v[228:231], a[120:123], a[80:83], v[228:231]
    ds_read_b128 a[188:191], v30 offset:24832
    v_cvt_pk_bf16_f32 v78, v196, v197
    v_mfma_f32_16x16x32_bf16 v[228:231], a[124:127], a[84:87], v[228:231]
    ds_read_b128 a[192:195], v31 offset:24832
    v_cvt_pk_bf16_f32 v79, v198, v199
    s_waitcnt vmcnt(4)
    ds_read_b128 v[160:163], v242 offset:18432
    ds_read_b128 v[164:167], v243 offset:18432
    s_add_u32 m0, s29, 49152
    s_mov_b32 s36, 49152
    buffer_load_dwordx4 v52, s[16:19], s36 offen offset:0 nt lds
    buffer_load_dwordx4 v53, s[16:19], s36 offen offset:1024 nt lds
    s_add_u32 m0, s29, 49152
    s_mov_b32 s36, 49152
    buffer_load_dwordx4 v54, s[16:19], s36 offen offset:2048 nt lds
    buffer_load_dwordx4 v55, s[16:19], s36 offen offset:3072 nt lds
    s_waitcnt lgkmcnt(1)
    v_lshlrev_b32 v168, 16, v160
    v_and_b32 v169, s3, v160
    v_lshlrev_b32 v170, 16, v161
    v_and_b32 v171, s3, v161
    v_lshlrev_b32 v172, 16, v162
    v_and_b32 v173, s3, v162
    v_lshlrev_b32 v174, 16, v163
    v_and_b32 v175, s3, v163
    v_pk_mul_f32 v[168:169], v[168:169], s[38:39]
    v_pk_mul_f32 v[170:171], v[170:171], s[38:39]
    v_pk_mul_f32 v[172:173], v[172:173], s[38:39]
    v_pk_mul_f32 v[174:175], v[174:175], s[38:39]
    v_cvt_pk_bf16_f32 v168, v168, v169
    v_cvt_pk_bf16_f32 v170, v170, v171
    v_cvt_pk_bf16_f32 v172, v172, v173
    v_cvt_pk_bf16_f32 v174, v174, v175
    v_accvgpr_write_b32 a88, v168
    v_accvgpr_write_b32 a89, v170
    v_accvgpr_write_b32 a90, v172
    v_accvgpr_write_b32 a91, v174
    s_waitcnt lgkmcnt(0)
    v_lshlrev_b32 v176, 16, v164
    v_and_b32 v177, s3, v164
    v_lshlrev_b32 v178, 16, v165
    v_and_b32 v179, s3, v165
    v_lshlrev_b32 v180, 16, v166
    v_and_b32 v181, s3, v166
    v_lshlrev_b32 v182, 16, v167
    v_and_b32 v183, s3, v167
    v_pk_mul_f32 v[176:177], v[176:177], s[38:39]
    v_pk_mul_f32 v[178:179], v[178:179], s[38:39]
    v_pk_mul_f32 v[180:181], v[180:181], s[38:39]
    v_pk_mul_f32 v[182:183], v[182:183], s[38:39]
    v_cvt_pk_bf16_f32 v176, v176, v177
    v_cvt_pk_bf16_f32 v178, v178, v179
    v_cvt_pk_bf16_f32 v180, v180, v181
    v_cvt_pk_bf16_f32 v182, v182, v183
    v_accvgpr_write_b32 a92, v176
    v_accvgpr_write_b32 a93, v178
    v_accvgpr_write_b32 a94, v180
    v_accvgpr_write_b32 a95, v182
    s_or_b32 s31, s30, s68
    s_or_b32 s33, s32, s68
    s_or_b32 s35, s34, s68
    v_mfma_f32_16x16x32_bf16 v[80:83], a[164:167], a[88:91], v[80:83]
    s_waitcnt vmcnt(4)
    v_mfma_f32_16x16x32_bf16 v[80:83], a[168:171], a[92:95], v[80:83]
    s_barrier
    ds_read_b128 a[96:99], v28 offset:32768
    v_mfma_f32_16x16x32_bf16 v[220:223], a[172:175], a[88:91], v[220:223]
    s_add_u32 m0, s29, 65536
    ds_read_b128 a[100:103], v29 offset:32768
    v_mfma_f32_16x16x32_bf16 v[220:223], a[176:179], a[92:95], v[220:223]
    s_mov_b32 s36, 65536
    ds_read_b128 a[104:107], v30 offset:32768
    v_mfma_f32_16x16x32_bf16 v[84:87], a[180:183], a[88:91], v[84:87]
    ds_read_b128 a[108:111], v31 offset:32768
    v_mfma_f32_16x16x32_bf16 v[84:87], a[184:187], a[92:95], v[84:87]
    ds_read_b128 a[112:115], v28 offset:33024
    v_max3_f32 v246, v80, v81, v82
    v_mfma_f32_16x16x32_bf16 v[228:231], a[188:191], a[88:91], v[228:231]
    ds_read_b128 a[116:119], v29 offset:33024
    v_max3_f32 v246, v246, v83, v254
    v_mfma_f32_16x16x32_bf16 v[228:231], a[192:195], a[92:95], v[228:231]
    s_waitcnt lgkmcnt(5)
    ds_read_b128 a[120:123], v30 offset:33024
    ds_read_b128 a[124:127], v31 offset:33024
    v_mfma_f32_16x16x32_bf16 v[88:91], a[96:99], a[0:3], v[16:19]
    s_waitcnt lgkmcnt(6)
    ds_read_b128 a[156:159], v31 offset:41216
    v_mov_b32 v238, v246
    v_mfma_f32_16x16x32_bf16 v[88:91], a[100:103], a[4:7], v[88:91]
    s_waitcnt lgkmcnt(6)
    buffer_load_dwordx4 v52, s[16:19], s36 offen offset:0 nt lds
    v_mfma_f32_16x16x32_bf16 v[88:91], a[104:107], a[8:11], v[88:91]
    s_waitcnt lgkmcnt(5)
    ds_read_b128 a[152:155], v30 offset:41216
    v_mfma_f32_16x16x32_bf16 v[88:91], a[108:111], a[12:15], v[88:91]
    s_waitcnt lgkmcnt(5)
    v_permlane32_swap_b32 v246, v238
    v_mfma_f32_16x16x32_bf16 v[88:91], a[112:115], a[16:19], v[88:91]
    s_waitcnt lgkmcnt(4)
    ds_read_b128 a[148:151], v29 offset:41216
    v_max_f32 v246, v246, v238
    v_mfma_f32_16x16x32_bf16 v[88:91], a[116:119], a[20:23], v[88:91]
    s_waitcnt lgkmcnt(4)
    v_mov_b32 v238, v246
    v_mfma_f32_16x16x32_bf16 v[88:91], a[120:123], a[24:27], v[88:91]
    s_waitcnt lgkmcnt(3)
    ds_read_b128 a[144:147], v28 offset:41216
    v_mfma_f32_16x16x32_bf16 v[88:91], a[124:127], a[28:31], v[88:91]
    v_permlane16_swap_b32 v246, v238
    v_mfma_f32_16x16x32_bf16 v[96:99], a[124:127], a[60:63], v[20:23]
    ds_read_b128 a[140:143], v31 offset:40960
    v_max_f32 v246, v246, v238
    v_mfma_f32_16x16x32_bf16 v[96:99], a[120:123], a[56:59], v[96:99]
    v_sub_f32 v24, 0, v246
    v_sub_f32 v25, 0, v246
    v_mfma_f32_16x16x32_bf16 v[96:99], a[116:119], a[52:55], v[96:99]
    ds_read_b128 a[136:139], v30 offset:40960
    v_sub_f32 v26, 0, v246
    v_mfma_f32_16x16x32_bf16 v[96:99], a[112:115], a[48:51], v[96:99]
    v_sub_f32 v27, 0, v246
    v_mfma_f32_16x16x32_bf16 v[96:99], a[108:111], a[44:47], v[96:99]
    ds_read_b128 a[132:135], v29 offset:40960
    v_mfma_f32_16x16x32_bf16 v[96:99], a[104:107], a[40:43], v[96:99]
    buffer_load_dwordx4 v53, s[16:19], s36 offen offset:1024 nt lds
    v_mfma_f32_16x16x32_bf16 v[96:99], a[100:103], a[36:39], v[96:99]
    ds_read_b128 a[128:131], v28 offset:40960
    v_mfma_f32_16x16x32_bf16 v[96:99], a[96:99], a[32:35], v[96:99]
    buffer_load_dwordx4 v54, s[16:19], s36 offen offset:2048 nt lds
    v_mfma_f32_16x16x32_bf16 v[104:107], a[96:99], a[64:67], v[24:27]
    v_exp_f32 v88, v88
    v_mfma_f32_16x16x32_bf16 v[104:107], a[100:103], a[68:71], v[104:107]
    v_exp_f32 v89, v89
    v_mfma_f32_16x16x32_bf16 v[104:107], a[104:107], a[72:75], v[104:107]
    buffer_load_dwordx4 v55, s[16:19], s36 offen offset:3072 nt lds
    v_mfma_f32_16x16x32_bf16 v[104:107], a[108:111], a[76:79], v[104:107]
    v_exp_f32 v90, v90
    v_mfma_f32_16x16x32_bf16 v[104:107], a[112:115], a[80:83], v[104:107]
    v_exp_f32 v91, v91
    v_mfma_f32_16x16x32_bf16 v[104:107], a[116:119], a[84:87], v[104:107]
    v_exp_f32 v96, v96
    v_mfma_f32_16x16x32_bf16 v[104:107], a[120:123], a[88:91], v[104:107]
    s_add_u32 m0, s29, 81920
    v_exp_f32 v97, v97
    v_mfma_f32_16x16x32_bf16 v[104:107], a[124:127], a[92:95], v[104:107]
    s_waitcnt vmcnt(4) lgkmcnt(0)
    v_exp_f32 v98, v98
    v_mfma_f32_16x16x32_bf16 v[12:15], a[156:159], a[92:95], v[24:27]
    s_barrier
    ds_read_b128 a[96:99], v28 offset:49152
    v_cvt_pk_bf16_f32 v88, v88, v89
    v_mfma_f32_16x16x32_bf16 v[12:15], a[152:155], a[88:91], v[12:15]
    s_mov_b32 s36, 81920
    v_exp_f32 v99, v99
    v_mfma_f32_16x16x32_bf16 v[12:15], a[148:151], a[84:87], v[12:15]
    ds_read_b128 a[100:103], v29 offset:49152
    v_cvt_pk_bf16_f32 v89, v90, v91
    v_mfma_f32_16x16x32_bf16 v[12:15], a[144:147], a[80:83], v[12:15]
    buffer_load_dwordx4 v52, s[16:19], s36 offen offset:0 nt lds
    v_mfma_f32_16x16x32_bf16 v[12:15], a[140:143], a[76:79], v[12:15]
    ds_read_b128 a[104:107], v30 offset:49152
    v_cvt_pk_bf16_f32 v96, v96, v97
    v_mfma_f32_16x16x32_bf16 v[12:15], a[136:139], a[72:75], v[12:15]
    v_exp_f32 v104, v104
    v_mfma_f32_16x16x32_bf16 v[12:15], a[132:135], a[68:71], v[12:15]
    ds_read_b128 a[108:111], v31 offset:49152
    v_cvt_pk_bf16_f32 v97, v98, v99
    v_mfma_f32_16x16x32_bf16 v[12:15], a[128:131], a[64:67], v[12:15]
    v_exp_f32 v105, v105
    v_mfma_f32_16x16x32_bf16 v[8:11], a[128:131], a[32:35], v[20:23]
    ds_read_b128 a[112:115], v28 offset:49408
    v_cvt_pk_bf16_f32 v104, v104, v105
    v_mfma_f32_16x16x32_bf16 v[8:11], a[132:135], a[36:39], v[8:11]
    v_exp_f32 v106, v106
    v_mfma_f32_16x16x32_bf16 v[8:11], a[136:139], a[40:43], v[8:11]
    ds_read_b128 a[116:119], v29 offset:49408
    v_mfma_f32_16x16x32_bf16 v[8:11], a[140:143], a[44:47], v[8:11]
    buffer_load_dwordx4 v53, s[16:19], s36 offen offset:1024 nt lds
    v_mfma_f32_16x16x32_bf16 v[8:11], a[144:147], a[48:51], v[8:11]
    ds_read_b128 a[120:123], v30 offset:49408
    v_mfma_f32_16x16x32_bf16 v[8:11], a[148:151], a[52:55], v[8:11]
    v_exp_f32 v107, v107
    v_mfma_f32_16x16x32_bf16 v[8:11], a[152:155], a[56:59], v[8:11]
    ds_read_b128 a[124:127], v31 offset:49408
    v_cvt_pk_bf16_f32 v105, v106, v107
    v_mfma_f32_16x16x32_bf16 v[8:11], a[156:159], a[60:63], v[8:11]
    v_exp_f32 v12, v12
    v_mfma_f32_16x16x32_bf16 v[4:7], a[156:159], a[28:31], v[16:19]
    v_exp_f32 v13, v13
    v_mfma_f32_16x16x32_bf16 v[4:7], a[152:155], a[24:27], v[4:7]
    v_exp_f32 v14, v14
    v_mfma_f32_16x16x32_bf16 v[4:7], a[148:151], a[20:23], v[4:7]
    buffer_load_dwordx4 v54, s[16:19], s36 offen offset:2048 nt lds
    v_mfma_f32_16x16x32_bf16 v[4:7], a[144:147], a[16:19], v[4:7]
    v_exp_f32 v15, v15
    v_mfma_f32_16x16x32_bf16 v[4:7], a[140:143], a[12:15], v[4:7]
    v_exp_f32 v8, v8
    v_mfma_f32_16x16x32_bf16 v[4:7], a[136:139], a[8:11], v[4:7]
    v_exp_f32 v9, v9
    v_mfma_f32_16x16x32_bf16 v[4:7], a[132:135], a[4:7], v[4:7]
    v_exp_f32 v10, v10
    v_mfma_f32_16x16x32_bf16 v[4:7], a[128:131], a[0:3], v[4:7]
    s_waitcnt lgkmcnt(0)
    v_exp_f32 v11, v11
    v_mfma_f32_16x16x32_bf16 v[92:95], a[96:99], a[0:3], v[16:19]
    ds_read_b128 a[156:159], v31 offset:57600
    v_cvt_pk_bf16_f32 v106, v12, v13
    v_mfma_f32_16x16x32_bf16 v[92:95], a[100:103], a[4:7], v[92:95]
    v_mfma_f32_16x16x32_bf16 v[92:95], a[104:107], a[8:11], v[92:95]
    ds_read_b128 a[152:155], v30 offset:57600
    v_cvt_pk_bf16_f32 v107, v14, v15
    v_mfma_f32_16x16x32_bf16 v[92:95], a[108:111], a[12:15], v[92:95]
    buffer_load_dwordx4 v55, s[16:19], s36 offen offset:3072 nt lds
    v_mfma_f32_16x16x32_bf16 v[92:95], a[112:115], a[16:19], v[92:95]
    ds_read_b128 a[148:151], v29 offset:57600
    v_cvt_pk_bf16_f32 v98, v8, v9
    v_mfma_f32_16x16x32_bf16 v[92:95], a[116:119], a[20:23], v[92:95]
    v_exp_f32 v4, v4
    v_mfma_f32_16x16x32_bf16 v[92:95], a[120:123], a[24:27], v[92:95]
    s_add_u32 m0, s29, 98304
    ds_read_b128 a[144:147], v28 offset:57600
    v_cvt_pk_bf16_f32 v99, v10, v11
    v_mfma_f32_16x16x32_bf16 v[92:95], a[124:127], a[28:31], v[92:95]
    s_mov_b32 s36, 98304
    v_exp_f32 v5, v5
    v_mfma_f32_16x16x32_bf16 v[100:103], a[124:127], a[60:63], v[20:23]
    ds_read_b128 a[140:143], v31 offset:57344
    v_cvt_pk_bf16_f32 v90, v4, v5
    v_mfma_f32_16x16x32_bf16 v[100:103], a[120:123], a[56:59], v[100:103]
    v_exp_f32 v6, v6
    v_mfma_f32_16x16x32_bf16 v[100:103], a[116:119], a[52:55], v[100:103]
    ds_read_b128 a[136:139], v30 offset:57344
    v_mfma_f32_16x16x32_bf16 v[100:103], a[112:115], a[48:51], v[100:103]
    buffer_load_dwordx4 v52, s[16:19], s36 offen offset:0 nt lds
    v_mfma_f32_16x16x32_bf16 v[100:103], a[108:111], a[44:47], v[100:103]
    ds_read_b128 a[132:135], v29 offset:57344
    v_mfma_f32_16x16x32_bf16 v[100:103], a[104:107], a[40:43], v[100:103]
    v_exp_f32 v7, v7
    v_mfma_f32_16x16x32_bf16 v[100:103], a[100:103], a[36:39], v[100:103]
    ds_read_b128 a[128:131], v28 offset:57344
    v_cvt_pk_bf16_f32 v91, v6, v7
    v_mfma_f32_16x16x32_bf16 v[100:103], a[96:99], a[32:35], v[100:103]
    v_exp_f32 v92, v92
    v_mfma_f32_16x16x32_bf16 v[108:111], a[96:99], a[64:67], v[24:27]
    v_exp_f32 v93, v93
    v_mfma_f32_16x16x32_bf16 v[108:111], a[100:103], a[68:71], v[108:111]
    v_exp_f32 v94, v94
    v_mfma_f32_16x16x32_bf16 v[108:111], a[104:107], a[72:75], v[108:111]
    v_exp_f32 v95, v95
    v_mfma_f32_16x16x32_bf16 v[108:111], a[108:111], a[76:79], v[108:111]
    v_mfma_f32_16x16x32_bf16 v[108:111], a[112:115], a[80:83], v[108:111]
    v_exp_f32 v100, v100
    v_mfma_f32_16x16x32_bf16 v[108:111], a[116:119], a[84:87], v[108:111]
    v_exp_f32 v101, v101
    v_mfma_f32_16x16x32_bf16 v[108:111], a[120:123], a[88:91], v[108:111]
    buffer_load_dwordx4 v53, s[16:19], s36 offen offset:1024 nt lds
    v_mfma_f32_16x16x32_bf16 v[108:111], a[124:127], a[92:95], v[108:111]
    s_waitcnt vmcnt(6) lgkmcnt(0)
    v_exp_f32 v102, v102
    v_mfma_f32_16x16x32_bf16 v[248:251], a[156:159], a[92:95], v[24:27]
    s_barrier
    ds_read_b128 a[96:99], v32 offset:0
    v_cvt_pk_bf16_f32 v92, v92, v93
    v_mfma_f32_16x16x32_bf16 v[248:251], a[152:155], a[88:91], v[248:251]
    v_exp_f32 v103, v103
    v_mfma_f32_16x16x32_bf16 v[248:251], a[148:151], a[84:87], v[248:251]
    ds_read_b128 a[100:103], v33 offset:0
    v_cvt_pk_bf16_f32 v93, v94, v95
    v_mfma_f32_16x16x32_bf16 v[248:251], a[144:147], a[80:83], v[248:251]
    v_mfma_f32_16x16x32_bf16 v[248:251], a[140:143], a[76:79], v[248:251]
    ds_read_b128 a[104:107], v34 offset:0
    v_cvt_pk_bf16_f32 v100, v100, v101
    v_mfma_f32_16x16x32_bf16 v[248:251], a[136:139], a[72:75], v[248:251]
    v_exp_f32 v108, v108
    v_mfma_f32_16x16x32_bf16 v[248:251], a[132:135], a[68:71], v[248:251]
    ds_read_b128 a[108:111], v35 offset:0
    v_cvt_pk_bf16_f32 v101, v102, v103
    v_mfma_f32_16x16x32_bf16 v[248:251], a[128:131], a[64:67], v[248:251]
    v_exp_f32 v109, v109
    v_mfma_f32_16x16x32_bf16 v[240:243], a[128:131], a[32:35], v[20:23]
    ds_read_b128 a[112:115], v32 offset:256
    v_cvt_pk_bf16_f32 v108, v108, v109
    v_mfma_f32_16x16x32_bf16 v[240:243], a[132:135], a[36:39], v[240:243]
    v_exp_f32 v110, v110
    v_mfma_f32_16x16x32_bf16 v[240:243], a[136:139], a[40:43], v[240:243]
    ds_read_b128 a[116:119], v33 offset:256
    v_mfma_f32_16x16x32_bf16 v[240:243], a[140:143], a[44:47], v[240:243]
    buffer_load_dwordx4 v54, s[16:19], s36 offen offset:2048 nt lds
    v_mfma_f32_16x16x32_bf16 v[240:243], a[144:147], a[48:51], v[240:243]
    ds_read_b128 a[120:123], v34 offset:256
    v_mfma_f32_16x16x32_bf16 v[240:243], a[148:151], a[52:55], v[240:243]
    v_exp_f32 v111, v111
    v_mfma_f32_16x16x32_bf16 v[240:243], a[152:155], a[56:59], v[240:243]
    ds_read_b128 a[124:127], v35 offset:256
    v_cvt_pk_bf16_f32 v109, v110, v111
    v_mfma_f32_16x16x32_bf16 v[240:243], a[156:159], a[60:63], v[240:243]
    v_exp_f32 v248, v248
    v_mfma_f32_16x16x32_bf16 v[232:235], a[156:159], a[28:31], v[16:19]
    v_exp_f32 v249, v249
    v_mfma_f32_16x16x32_bf16 v[232:235], a[152:155], a[24:27], v[232:235]
    v_exp_f32 v250, v250
    v_mfma_f32_16x16x32_bf16 v[232:235], a[148:151], a[20:23], v[232:235]
    v_exp_f32 v251, v251
    v_mfma_f32_16x16x32_bf16 v[232:235], a[144:147], a[16:19], v[232:235]
    v_mfma_f32_16x16x32_bf16 v[232:235], a[140:143], a[12:15], v[232:235]
    v_exp_f32 v240, v240
    v_mfma_f32_16x16x32_bf16 v[232:235], a[136:139], a[8:11], v[232:235]
    v_exp_f32 v241, v241
    v_mfma_f32_16x16x32_bf16 v[232:235], a[132:135], a[4:7], v[232:235]
    buffer_load_dwordx4 v55, s[16:19], s36 offen offset:3072 nt lds
    v_mfma_f32_16x16x32_bf16 v[232:235], a[128:131], a[0:3], v[232:235]
    s_waitcnt lgkmcnt(0)
    v_exp_f32 v242, v242
    v_mfma_f32_16x16x32_bf16 v[112:115], a[96:99], a[0:3], v[16:19]
    ds_read_b128 a[156:159], v35 offset:8448
    v_cvt_pk_bf16_f32 v110, v248, v249
    v_mfma_f32_16x16x32_bf16 v[112:115], a[100:103], a[4:7], v[112:115]
    v_exp_f32 v243, v243
    v_mfma_f32_16x16x32_bf16 v[112:115], a[104:107], a[8:11], v[112:115]
    ds_read_b128 a[152:155], v34 offset:8448
    v_cvt_pk_bf16_f32 v111, v250, v251
    v_mfma_f32_16x16x32_bf16 v[112:115], a[108:111], a[12:15], v[112:115]
    v_mfma_f32_16x16x32_bf16 v[112:115], a[112:115], a[16:19], v[112:115]
    ds_read_b128 a[148:151], v33 offset:8448
    v_cvt_pk_bf16_f32 v102, v240, v241
    v_mfma_f32_16x16x32_bf16 v[112:115], a[116:119], a[20:23], v[112:115]
    v_exp_f32 v232, v232
    v_mfma_f32_16x16x32_bf16 v[112:115], a[120:123], a[24:27], v[112:115]
    s_add_u32 m0, s29, 114688
    ds_read_b128 a[144:147], v32 offset:8448
    v_cvt_pk_bf16_f32 v103, v242, v243
    v_mfma_f32_16x16x32_bf16 v[112:115], a[124:127], a[28:31], v[112:115]
L_pad1:
    s_cbranch_execz L_pad5
    s_mov_b32 s36, 114688
    v_exp_f32 v233, v233
    v_mfma_f32_16x16x32_bf16 v[120:123], a[124:127], a[60:63], v[20:23]
    ds_read_b128 a[140:143], v35 offset:8192
    v_cvt_pk_bf16_f32 v94, v232, v233
    v_mfma_f32_16x16x32_bf16 v[120:123], a[120:123], a[56:59], v[120:123]
    v_exp_f32 v234, v234
    v_mfma_f32_16x16x32_bf16 v[120:123], a[116:119], a[52:55], v[120:123]
    ds_read_b128 a[136:139], v34 offset:8192
    v_mfma_f32_16x16x32_bf16 v[120:123], a[112:115], a[48:51], v[120:123]
    buffer_load_dwordx4 v52, s[16:19], s36 offen offset:0 nt lds
    v_mfma_f32_16x16x32_bf16 v[120:123], a[108:111], a[44:47], v[120:123]
    ds_read_b128 a[132:135], v33 offset:8192
    v_mfma_f32_16x16x32_bf16 v[120:123], a[104:107], a[40:43], v[120:123]
    v_exp_f32 v235, v235
    v_mfma_f32_16x16x32_bf16 v[120:123], a[100:103], a[36:39], v[120:123]
    ds_read_b128 a[128:131], v32 offset:8192
    v_cvt_pk_bf16_f32 v95, v234, v235
    v_mfma_f32_16x16x32_bf16 v[120:123], a[96:99], a[32:35], v[120:123]
    v_exp_f32 v112, v112
    v_mfma_f32_16x16x32_bf16 v[128:131], a[96:99], a[64:67], v[24:27]
    v_exp_f32 v113, v113
    v_mfma_f32_16x16x32_bf16 v[128:131], a[100:103], a[68:71], v[128:131]
    v_exp_f32 v114, v114
    v_mfma_f32_16x16x32_bf16 v[128:131], a[104:107], a[72:75], v[128:131]
    v_exp_f32 v115, v115
    v_mfma_f32_16x16x32_bf16 v[128:131], a[108:111], a[76:79], v[128:131]
    v_mfma_f32_16x16x32_bf16 v[128:131], a[112:115], a[80:83], v[128:131]
    v_exp_f32 v120, v120
    v_mfma_f32_16x16x32_bf16 v[128:131], a[116:119], a[84:87], v[128:131]
    v_exp_f32 v121, v121
    v_mfma_f32_16x16x32_bf16 v[128:131], a[120:123], a[88:91], v[128:131]
    buffer_load_dwordx4 v53, s[16:19], s36 offen offset:1024 nt lds
    v_mfma_f32_16x16x32_bf16 v[128:131], a[124:127], a[92:95], v[128:131]
    s_waitcnt vmcnt(6) lgkmcnt(0)
    v_exp_f32 v122, v122
    v_mfma_f32_16x16x32_bf16 v[12:15], a[156:159], a[92:95], v[24:27]
    s_barrier
    ds_read_b128 a[96:99], v32 offset:16384
    v_cvt_pk_bf16_f32 v112, v112, v113
    v_mfma_f32_16x16x32_bf16 v[12:15], a[152:155], a[88:91], v[12:15]
    v_exp_f32 v123, v123
    v_mfma_f32_16x16x32_bf16 v[12:15], a[148:151], a[84:87], v[12:15]
    ds_read_b128 a[100:103], v33 offset:16384
    v_cvt_pk_bf16_f32 v113, v114, v115
    v_mfma_f32_16x16x32_bf16 v[12:15], a[144:147], a[80:83], v[12:15]
    v_mfma_f32_16x16x32_bf16 v[12:15], a[140:143], a[76:79], v[12:15]
    ds_read_b128 a[104:107], v34 offset:16384
    v_cvt_pk_bf16_f32 v120, v120, v121
    v_mfma_f32_16x16x32_bf16 v[12:15], a[136:139], a[72:75], v[12:15]
    v_exp_f32 v128, v128
    v_mfma_f32_16x16x32_bf16 v[12:15], a[132:135], a[68:71], v[12:15]
    ds_read_b128 a[108:111], v35 offset:16384
    v_cvt_pk_bf16_f32 v121, v122, v123
    v_mfma_f32_16x16x32_bf16 v[12:15], a[128:131], a[64:67], v[12:15]
    v_exp_f32 v129, v129
    v_mfma_f32_16x16x32_bf16 v[8:11], a[128:131], a[32:35], v[20:23]
    ds_read_b128 a[112:115], v32 offset:16640
    v_cvt_pk_bf16_f32 v128, v128, v129
    v_mfma_f32_16x16x32_bf16 v[8:11], a[132:135], a[36:39], v[8:11]
    v_exp_f32 v130, v130
    v_mfma_f32_16x16x32_bf16 v[8:11], a[136:139], a[40:43], v[8:11]
    ds_read_b128 a[116:119], v33 offset:16640
    v_mfma_f32_16x16x32_bf16 v[8:11], a[140:143], a[44:47], v[8:11]
    buffer_load_dwordx4 v54, s[16:19], s36 offen offset:2048 nt lds
    v_mfma_f32_16x16x32_bf16 v[8:11], a[144:147], a[48:51], v[8:11]
    ds_read_b128 a[120:123], v34 offset:16640
    v_mfma_f32_16x16x32_bf16 v[8:11], a[148:151], a[52:55], v[8:11]
    v_exp_f32 v131, v131
    v_mfma_f32_16x16x32_bf16 v[8:11], a[152:155], a[56:59], v[8:11]
    ds_read_b128 a[124:127], v35 offset:16640
    v_cvt_pk_bf16_f32 v129, v130, v131
    v_mfma_f32_16x16x32_bf16 v[8:11], a[156:159], a[60:63], v[8:11]
    v_exp_f32 v12, v12
    v_mfma_f32_16x16x32_bf16 v[4:7], a[156:159], a[28:31], v[16:19]
    v_exp_f32 v13, v13
    v_mfma_f32_16x16x32_bf16 v[4:7], a[152:155], a[24:27], v[4:7]
    v_exp_f32 v14, v14
    v_mfma_f32_16x16x32_bf16 v[4:7], a[148:151], a[20:23], v[4:7]
    v_exp_f32 v15, v15
    v_mfma_f32_16x16x32_bf16 v[4:7], a[144:147], a[16:19], v[4:7]
    v_mfma_f32_16x16x32_bf16 v[4:7], a[140:143], a[12:15], v[4:7]
    v_exp_f32 v8, v8
    v_mfma_f32_16x16x32_bf16 v[4:7], a[136:139], a[8:11], v[4:7]
    v_exp_f32 v9, v9
    v_mfma_f32_16x16x32_bf16 v[4:7], a[132:135], a[4:7], v[4:7]
    buffer_load_dwordx4 v55, s[16:19], s36 offen offset:3072 nt lds
    v_mfma_f32_16x16x32_bf16 v[4:7], a[128:131], a[0:3], v[4:7]
    s_waitcnt lgkmcnt(0)
    v_exp_f32 v10, v10
    v_mfma_f32_16x16x32_bf16 v[116:119], a[96:99], a[0:3], v[16:19]
    ds_read_b128 a[156:159], v35 offset:24832
    v_cvt_pk_bf16_f32 v130, v12, v13
    v_mfma_f32_16x16x32_bf16 v[116:119], a[100:103], a[4:7], v[116:119]
    v_exp_f32 v11, v11
    v_mfma_f32_16x16x32_bf16 v[116:119], a[104:107], a[8:11], v[116:119]
    ds_read_b128 a[152:155], v34 offset:24832
    v_cvt_pk_bf16_f32 v131, v14, v15
    v_mfma_f32_16x16x32_bf16 v[116:119], a[108:111], a[12:15], v[116:119]
    v_mfma_f32_16x16x32_bf16 v[116:119], a[112:115], a[16:19], v[116:119]
    ds_read_b128 a[148:151], v33 offset:24832
    v_cvt_pk_bf16_f32 v122, v8, v9
    v_mfma_f32_16x16x32_bf16 v[116:119], a[116:119], a[20:23], v[116:119]
    v_exp_f32 v4, v4
    v_mfma_f32_16x16x32_bf16 v[116:119], a[120:123], a[24:27], v[116:119]
    s_add_u32 m0, s29, 131072
    ds_read_b128 a[144:147], v32 offset:24832
    v_cvt_pk_bf16_f32 v123, v10, v11
    v_mfma_f32_16x16x32_bf16 v[116:119], a[124:127], a[28:31], v[116:119]
    s_mov_b32 s36, 131072
    v_exp_f32 v5, v5
    v_mfma_f32_16x16x32_bf16 v[124:127], a[124:127], a[60:63], v[20:23]
    ds_read_b128 a[140:143], v35 offset:24576
    v_cvt_pk_bf16_f32 v114, v4, v5
    v_mfma_f32_16x16x32_bf16 v[124:127], a[120:123], a[56:59], v[124:127]
    v_exp_f32 v6, v6
    v_mfma_f32_16x16x32_bf16 v[124:127], a[116:119], a[52:55], v[124:127]
    ds_read_b128 a[136:139], v34 offset:24576
    v_mfma_f32_16x16x32_bf16 v[124:127], a[112:115], a[48:51], v[124:127]
    buffer_load_dwordx4 v52, s[16:19], s36 offen offset:0 nt lds
    v_mfma_f32_16x16x32_bf16 v[124:127], a[108:111], a[44:47], v[124:127]
    ds_read_b128 a[132:135], v33 offset:24576
    v_mfma_f32_16x16x32_bf16 v[124:127], a[104:107], a[40:43], v[124:127]
    v_exp_f32 v7, v7
    v_mfma_f32_16x16x32_bf16 v[124:127], a[100:103], a[36:39], v[124:127]
    ds_read_b128 a[128:131], v32 offset:24576
    v_cvt_pk_bf16_f32 v115, v6, v7
    v_mfma_f32_16x16x32_bf16 v[124:127], a[96:99], a[32:35], v[124:127]
    v_exp_f32 v116, v116
    v_mfma_f32_16x16x32_bf16 v[132:135], a[96:99], a[64:67], v[24:27]
    v_exp_f32 v117, v117
    v_mfma_f32_16x16x32_bf16 v[132:135], a[100:103], a[68:71], v[132:135]
    v_exp_f32 v118, v118
    v_mfma_f32_16x16x32_bf16 v[132:135], a[104:107], a[72:75], v[132:135]
    v_exp_f32 v119, v119
    v_mfma_f32_16x16x32_bf16 v[132:135], a[108:111], a[76:79], v[132:135]
    v_mfma_f32_16x16x32_bf16 v[132:135], a[112:115], a[80:83], v[132:135]
    v_exp_f32 v124, v124
    v_mfma_f32_16x16x32_bf16 v[132:135], a[116:119], a[84:87], v[132:135]
    v_exp_f32 v125, v125
    v_mfma_f32_16x16x32_bf16 v[132:135], a[120:123], a[88:91], v[132:135]
    buffer_load_dwordx4 v53, s[16:19], s36 offen offset:1024 nt lds
    v_mfma_f32_16x16x32_bf16 v[132:135], a[124:127], a[92:95], v[132:135]
    s_waitcnt vmcnt(6) lgkmcnt(0)
    v_exp_f32 v126, v126
    v_mfma_f32_16x16x32_bf16 v[248:251], a[156:159], a[92:95], v[24:27]
    s_barrier
    ds_read_b128 a[96:99], v32 offset:32768
    v_cvt_pk_bf16_f32 v116, v116, v117
    v_mfma_f32_16x16x32_bf16 v[248:251], a[152:155], a[88:91], v[248:251]
    v_exp_f32 v127, v127
    v_mfma_f32_16x16x32_bf16 v[248:251], a[148:151], a[84:87], v[248:251]
    ds_read_b128 a[100:103], v33 offset:32768
    v_cvt_pk_bf16_f32 v117, v118, v119
    v_mfma_f32_16x16x32_bf16 v[248:251], a[144:147], a[80:83], v[248:251]
    v_mfma_f32_16x16x32_bf16 v[248:251], a[140:143], a[76:79], v[248:251]
    ds_read_b128 a[104:107], v34 offset:32768
    v_cvt_pk_bf16_f32 v124, v124, v125
    v_mfma_f32_16x16x32_bf16 v[248:251], a[136:139], a[72:75], v[248:251]
    v_exp_f32 v132, v132
    v_mfma_f32_16x16x32_bf16 v[248:251], a[132:135], a[68:71], v[248:251]
    ds_read_b128 a[108:111], v35 offset:32768
    v_cvt_pk_bf16_f32 v125, v126, v127
    v_mfma_f32_16x16x32_bf16 v[248:251], a[128:131], a[64:67], v[248:251]
    v_exp_f32 v133, v133
    v_mfma_f32_16x16x32_bf16 v[240:243], a[128:131], a[32:35], v[20:23]
    ds_read_b128 a[112:115], v32 offset:33024
    v_cvt_pk_bf16_f32 v132, v132, v133
    v_mfma_f32_16x16x32_bf16 v[240:243], a[132:135], a[36:39], v[240:243]
    v_exp_f32 v134, v134
    v_mfma_f32_16x16x32_bf16 v[240:243], a[136:139], a[40:43], v[240:243]
    ds_read_b128 a[116:119], v33 offset:33024
    v_mfma_f32_16x16x32_bf16 v[240:243], a[140:143], a[44:47], v[240:243]
    buffer_load_dwordx4 v54, s[16:19], s36 offen offset:2048 nt lds
    v_mfma_f32_16x16x32_bf16 v[240:243], a[144:147], a[48:51], v[240:243]
    ds_read_b128 a[120:123], v34 offset:33024
    v_mfma_f32_16x16x32_bf16 v[240:243], a[148:151], a[52:55], v[240:243]
    v_exp_f32 v135, v135
    v_mfma_f32_16x16x32_bf16 v[240:243], a[152:155], a[56:59], v[240:243]
    ds_read_b128 a[124:127], v35 offset:33024
    v_cvt_pk_bf16_f32 v133, v134, v135
    v_mfma_f32_16x16x32_bf16 v[240:243], a[156:159], a[60:63], v[240:243]
    v_exp_f32 v248, v248
    v_mfma_f32_16x16x32_bf16 v[232:235], a[156:159], a[28:31], v[16:19]
    v_exp_f32 v249, v249
    v_mfma_f32_16x16x32_bf16 v[232:235], a[152:155], a[24:27], v[232:235]
    v_exp_f32 v250, v250
    v_mfma_f32_16x16x32_bf16 v[232:235], a[148:151], a[20:23], v[232:235]
    v_exp_f32 v251, v251
    v_mfma_f32_16x16x32_bf16 v[232:235], a[144:147], a[16:19], v[232:235]
    v_mfma_f32_16x16x32_bf16 v[232:235], a[140:143], a[12:15], v[232:235]
    v_exp_f32 v240, v240
    v_mfma_f32_16x16x32_bf16 v[232:235], a[136:139], a[8:11], v[232:235]
    v_exp_f32 v241, v241
    v_mfma_f32_16x16x32_bf16 v[232:235], a[132:135], a[4:7], v[232:235]
    buffer_load_dwordx4 v55, s[16:19], s36 offen offset:3072 nt lds
    v_mfma_f32_16x16x32_bf16 v[232:235], a[128:131], a[0:3], v[232:235]
    s_waitcnt lgkmcnt(0)
    v_exp_f32 v242, v242
    v_mfma_f32_16x16x32_bf16 v[136:139], a[96:99], a[0:3], v[16:19]
    ds_read_b128 a[156:159], v35 offset:41216
    v_cvt_pk_bf16_f32 v134, v248, v249
    v_mfma_f32_16x16x32_bf16 v[136:139], a[100:103], a[4:7], v[136:139]
    v_exp_f32 v243, v243
    v_mfma_f32_16x16x32_bf16 v[136:139], a[104:107], a[8:11], v[136:139]
    ds_read_b128 a[152:155], v34 offset:41216
    v_cvt_pk_bf16_f32 v135, v250, v251
    v_mfma_f32_16x16x32_bf16 v[136:139], a[108:111], a[12:15], v[136:139]
    v_mfma_f32_16x16x32_bf16 v[136:139], a[112:115], a[16:19], v[136:139]
    ds_read_b128 a[148:151], v33 offset:41216
    v_cvt_pk_bf16_f32 v126, v240, v241
    v_mfma_f32_16x16x32_bf16 v[136:139], a[116:119], a[20:23], v[136:139]
    v_exp_f32 v232, v232
    v_mfma_f32_16x16x32_bf16 v[136:139], a[120:123], a[24:27], v[136:139]
    s_add_u32 m0, s29, 147456
    ds_read_b128 a[144:147], v32 offset:41216
    v_cvt_pk_bf16_f32 v127, v242, v243
    v_mfma_f32_16x16x32_bf16 v[136:139], a[124:127], a[28:31], v[136:139]
    s_mov_b32 s36, 147456
    v_exp_f32 v233, v233
    v_mfma_f32_16x16x32_bf16 v[144:147], a[124:127], a[60:63], v[20:23]
    ds_read_b128 a[140:143], v35 offset:40960
    v_cvt_pk_bf16_f32 v118, v232, v233
    v_mfma_f32_16x16x32_bf16 v[144:147], a[120:123], a[56:59], v[144:147]
    v_exp_f32 v234, v234
    v_mfma_f32_16x16x32_bf16 v[144:147], a[116:119], a[52:55], v[144:147]
    ds_read_b128 a[136:139], v34 offset:40960
    v_mfma_f32_16x16x32_bf16 v[144:147], a[112:115], a[48:51], v[144:147]
    buffer_load_dwordx4 v52, s[16:19], s36 offen offset:0 nt lds
    v_mfma_f32_16x16x32_bf16 v[144:147], a[108:111], a[44:47], v[144:147]
    ds_read_b128 a[132:135], v33 offset:40960
    v_mfma_f32_16x16x32_bf16 v[144:147], a[104:107], a[40:43], v[144:147]
    v_exp_f32 v235, v235
    v_mfma_f32_16x16x32_bf16 v[144:147], a[100:103], a[36:39], v[144:147]
    ds_read_b128 a[128:131], v32 offset:40960
    v_cvt_pk_bf16_f32 v119, v234, v235
    v_mfma_f32_16x16x32_bf16 v[144:147], a[96:99], a[32:35], v[144:147]
    v_exp_f32 v136, v136
    v_mfma_f32_16x16x32_bf16 v[152:155], a[96:99], a[64:67], v[24:27]
    v_exp_f32 v137, v137
    v_mfma_f32_16x16x32_bf16 v[152:155], a[100:103], a[68:71], v[152:155]
    v_exp_f32 v138, v138
    v_mfma_f32_16x16x32_bf16 v[152:155], a[104:107], a[72:75], v[152:155]
    v_exp_f32 v139, v139
    v_mfma_f32_16x16x32_bf16 v[152:155], a[108:111], a[76:79], v[152:155]
    v_mfma_f32_16x16x32_bf16 v[152:155], a[112:115], a[80:83], v[152:155]
    v_exp_f32 v144, v144
    v_mfma_f32_16x16x32_bf16 v[152:155], a[116:119], a[84:87], v[152:155]
    v_exp_f32 v145, v145
    v_mfma_f32_16x16x32_bf16 v[152:155], a[120:123], a[88:91], v[152:155]
    buffer_load_dwordx4 v53, s[16:19], s36 offen offset:1024 nt lds
    v_mfma_f32_16x16x32_bf16 v[152:155], a[124:127], a[92:95], v[152:155]
    s_waitcnt vmcnt(6) lgkmcnt(0)
    v_exp_f32 v146, v146
    v_mfma_f32_16x16x32_bf16 v[12:15], a[156:159], a[92:95], v[24:27]
    s_barrier
    ds_read_b128 a[96:99], v32 offset:49152
    v_cvt_pk_bf16_f32 v136, v136, v137
    v_mfma_f32_16x16x32_bf16 v[12:15], a[152:155], a[88:91], v[12:15]
    v_exp_f32 v147, v147
    v_mfma_f32_16x16x32_bf16 v[12:15], a[148:151], a[84:87], v[12:15]
    ds_read_b128 a[100:103], v33 offset:49152
    v_cvt_pk_bf16_f32 v137, v138, v139
    v_mfma_f32_16x16x32_bf16 v[12:15], a[144:147], a[80:83], v[12:15]
    v_mfma_f32_16x16x32_bf16 v[12:15], a[140:143], a[76:79], v[12:15]
    ds_read_b128 a[104:107], v34 offset:49152
    v_cvt_pk_bf16_f32 v144, v144, v145
    v_mfma_f32_16x16x32_bf16 v[12:15], a[136:139], a[72:75], v[12:15]
    v_exp_f32 v152, v152
    v_mfma_f32_16x16x32_bf16 v[12:15], a[132:135], a[68:71], v[12:15]
    ds_read_b128 a[108:111], v35 offset:49152
    v_cvt_pk_bf16_f32 v145, v146, v147
    v_mfma_f32_16x16x32_bf16 v[12:15], a[128:131], a[64:67], v[12:15]
    v_exp_f32 v153, v153
    v_mfma_f32_16x16x32_bf16 v[8:11], a[128:131], a[32:35], v[20:23]
    ds_read_b128 a[112:115], v32 offset:49408
    v_cvt_pk_bf16_f32 v152, v152, v153
    v_mfma_f32_16x16x32_bf16 v[8:11], a[132:135], a[36:39], v[8:11]
    v_exp_f32 v154, v154
    v_mfma_f32_16x16x32_bf16 v[8:11], a[136:139], a[40:43], v[8:11]
    ds_read_b128 a[116:119], v33 offset:49408
    v_mfma_f32_16x16x32_bf16 v[8:11], a[140:143], a[44:47], v[8:11]
    buffer_load_dwordx4 v54, s[16:19], s36 offen offset:2048 nt lds
    v_mfma_f32_16x16x32_bf16 v[8:11], a[144:147], a[48:51], v[8:11]
    ds_read_b128 a[120:123], v34 offset:49408
    v_mfma_f32_16x16x32_bf16 v[8:11], a[148:151], a[52:55], v[8:11]
    v_exp_f32 v155, v155
    v_mfma_f32_16x16x32_bf16 v[8:11], a[152:155], a[56:59], v[8:11]
    ds_read_b128 a[124:127], v35 offset:49408
    v_cvt_pk_bf16_f32 v153, v154, v155
    v_mfma_f32_16x16x32_bf16 v[8:11], a[156:159], a[60:63], v[8:11]
    v_exp_f32 v12, v12
    v_mfma_f32_16x16x32_bf16 v[4:7], a[156:159], a[28:31], v[16:19]
    v_exp_f32 v13, v13
    v_mfma_f32_16x16x32_bf16 v[4:7], a[152:155], a[24:27], v[4:7]
    v_exp_f32 v14, v14
    v_mfma_f32_16x16x32_bf16 v[4:7], a[148:151], a[20:23], v[4:7]
    v_exp_f32 v15, v15
    v_mfma_f32_16x16x32_bf16 v[4:7], a[144:147], a[16:19], v[4:7]
    v_sub_f32 v80, v80, v246
    v_sub_f32 v81, v81, v246
    v_mfma_f32_16x16x32_bf16 v[4:7], a[140:143], a[12:15], v[4:7]
    v_exp_f32 v8, v8
    v_mfma_f32_16x16x32_bf16 v[4:7], a[136:139], a[8:11], v[4:7]
    v_exp_f32 v9, v9
    v_mfma_f32_16x16x32_bf16 v[4:7], a[132:135], a[4:7], v[4:7]
    buffer_load_dwordx4 v55, s[16:19], s36 offen offset:3072 nt lds
    v_mfma_f32_16x16x32_bf16 v[4:7], a[128:131], a[0:3], v[4:7]
    s_waitcnt lgkmcnt(0)
    v_exp_f32 v10, v10
    v_mfma_f32_16x16x32_bf16 v[140:143], a[96:99], a[0:3], v[16:19]
    ds_read_b128 a[156:159], v35 offset:57600
    v_cvt_pk_bf16_f32 v154, v12, v13
    v_mfma_f32_16x16x32_bf16 v[140:143], a[100:103], a[4:7], v[140:143]
    v_exp_f32 v11, v11
    v_mfma_f32_16x16x32_bf16 v[140:143], a[104:107], a[8:11], v[140:143]
    ds_read_b128 a[152:155], v34 offset:57600
    v_cvt_pk_bf16_f32 v155, v14, v15
    v_mfma_f32_16x16x32_bf16 v[140:143], a[108:111], a[12:15], v[140:143]
    v_sub_f32 v82, v82, v246
    v_sub_f32 v83, v83, v246
    v_mfma_f32_16x16x32_bf16 v[140:143], a[112:115], a[16:19], v[140:143]
    ds_read_b128 a[148:151], v33 offset:57600
    v_cvt_pk_bf16_f32 v146, v8, v9
    v_mfma_f32_16x16x32_bf16 v[140:143], a[116:119], a[20:23], v[140:143]
    v_exp_f32 v4, v4
    v_mfma_f32_16x16x32_bf16 v[140:143], a[120:123], a[24:27], v[140:143]
    s_add_u32 m0, s29, 0
    ds_read_b128 a[144:147], v32 offset:57600
    v_cvt_pk_bf16_f32 v147, v10, v11
    v_mfma_f32_16x16x32_bf16 v[140:143], a[124:127], a[28:31], v[140:143]
    s_mov_b32 s36, 163840
    v_exp_f32 v5, v5
    v_mfma_f32_16x16x32_bf16 v[148:151], a[124:127], a[60:63], v[20:23]
    ds_read_b128 a[140:143], v35 offset:57344
    v_cvt_pk_bf16_f32 v138, v4, v5
    v_mfma_f32_16x16x32_bf16 v[148:151], a[120:123], a[56:59], v[148:151]
    v_exp_f32 v6, v6
    v_mfma_f32_16x16x32_bf16 v[148:151], a[116:119], a[52:55], v[148:151]
    ds_read_b128 a[136:139], v34 offset:57344
    v_sub_f32 v220, v220, v246
    v_mfma_f32_16x16x32_bf16 v[148:151], a[112:115], a[48:51], v[148:151]
    buffer_load_dwordx4 v52, s[16:19], s36 offen offset:0 nt lds
    v_mfma_f32_16x16x32_bf16 v[148:151], a[108:111], a[44:47], v[148:151]
    ds_read_b128 a[132:135], v33 offset:57344
    v_sub_f32 v221, v221, v246
    v_mfma_f32_16x16x32_bf16 v[148:151], a[104:107], a[40:43], v[148:151]
    v_exp_f32 v7, v7
    v_mfma_f32_16x16x32_bf16 v[148:151], a[100:103], a[36:39], v[148:151]
    ds_read_b128 a[128:131], v32 offset:57344
    v_cvt_pk_bf16_f32 v139, v6, v7
    v_mfma_f32_16x16x32_bf16 v[148:151], a[96:99], a[32:35], v[148:151]
    v_exp_f32 v140, v140
    v_mfma_f32_16x16x32_bf16 v[156:159], a[96:99], a[64:67], v[24:27]
    v_exp_f32 v141, v141
    v_mfma_f32_16x16x32_bf16 v[156:159], a[100:103], a[68:71], v[156:159]
    v_exp_f32 v142, v142
    v_mfma_f32_16x16x32_bf16 v[156:159], a[104:107], a[72:75], v[156:159]
    v_exp_f32 v143, v143
    v_mfma_f32_16x16x32_bf16 v[156:159], a[108:111], a[76:79], v[156:159]
    v_exp_f32 v80, v80
    v_mfma_f32_16x16x32_bf16 v[156:159], a[112:115], a[80:83], v[156:159]
    v_exp_f32 v148, v148
    v_mfma_f32_16x16x32_bf16 v[156:159], a[116:119], a[84:87], v[156:159]
    v_exp_f32 v149, v149
    v_mfma_f32_16x16x32_bf16 v[156:159], a[120:123], a[88:91], v[156:159]
    buffer_load_dwordx4 v53, s[16:19], s36 offen offset:1024 nt lds
    v_mfma_f32_16x16x32_bf16 v[156:159], a[124:127], a[92:95], v[156:159]
    s_waitcnt vmcnt(6) lgkmcnt(0)
    v_exp_f32 v150, v150
    v_mfma_f32_16x16x32_bf16 v[248:251], a[156:159], a[92:95], v[24:27]
    s_barrier
    ds_read_b128 a[96:99], v36 offset:0
    v_cvt_pk_bf16_f32 v140, v140, v141
    v_mfma_f32_16x16x32_bf16 v[248:251], a[152:155], a[88:91], v[248:251]
    v_exp_f32 v151, v151
    v_mfma_f32_16x16x32_bf16 v[248:251], a[148:151], a[84:87], v[248:251]
    ds_read_b128 a[100:103], v37 offset:0
    v_cvt_pk_bf16_f32 v141, v142, v143
    v_mfma_f32_16x16x32_bf16 v[248:251], a[144:147], a[80:83], v[248:251]
    v_exp_f32 v81, v81
    v_mfma_f32_16x16x32_bf16 v[248:251], a[140:143], a[76:79], v[248:251]
    ds_read_b128 a[104:107], v38 offset:0
    v_cvt_pk_bf16_f32 v148, v148, v149
    v_mfma_f32_16x16x32_bf16 v[248:251], a[136:139], a[72:75], v[248:251]
    v_exp_f32 v156, v156
    v_mfma_f32_16x16x32_bf16 v[248:251], a[132:135], a[68:71], v[248:251]
    ds_read_b128 a[108:111], v39 offset:0
    v_cvt_pk_bf16_f32 v149, v150, v151
    v_mfma_f32_16x16x32_bf16 v[248:251], a[128:131], a[64:67], v[248:251]
    v_exp_f32 v157, v157
    v_mfma_f32_16x16x32_bf16 v[240:243], a[128:131], a[32:35], v[20:23]
    ds_read_b128 a[112:115], v36 offset:256
    v_cvt_pk_bf16_f32 v156, v156, v157
    v_mfma_f32_16x16x32_bf16 v[240:243], a[132:135], a[36:39], v[240:243]
    v_exp_f32 v158, v158
    v_mfma_f32_16x16x32_bf16 v[240:243], a[136:139], a[40:43], v[240:243]
    ds_read_b128 a[116:119], v37 offset:256
    v_sub_f32 v222, v222, v246
    v_mfma_f32_16x16x32_bf16 v[240:243], a[140:143], a[44:47], v[240:243]
    buffer_load_dwordx4 v54, s[16:19], s36 offen offset:2048 nt lds
    v_mfma_f32_16x16x32_bf16 v[240:243], a[144:147], a[48:51], v[240:243]
    ds_read_b128 a[120:123], v38 offset:256
    v_sub_f32 v223, v223, v246
    v_mfma_f32_16x16x32_bf16 v[240:243], a[148:151], a[52:55], v[240:243]
    v_exp_f32 v159, v159
    v_mfma_f32_16x16x32_bf16 v[240:243], a[152:155], a[56:59], v[240:243]
    ds_read_b128 a[124:127], v39 offset:256
    v_cvt_pk_bf16_f32 v157, v158, v159
    v_mfma_f32_16x16x32_bf16 v[240:243], a[156:159], a[60:63], v[240:243]
    v_exp_f32 v248, v248
    v_mfma_f32_16x16x32_bf16 v[232:235], a[156:159], a[28:31], v[16:19]
    v_exp_f32 v249, v249
    v_mfma_f32_16x16x32_bf16 v[232:235], a[152:155], a[24:27], v[232:235]
    v_exp_f32 v250, v250
    v_mfma_f32_16x16x32_bf16 v[232:235], a[148:151], a[20:23], v[232:235]
    v_exp_f32 v251, v251
    v_mfma_f32_16x16x32_bf16 v[232:235], a[144:147], a[16:19], v[232:235]
    v_exp_f32 v82, v82
    v_mfma_f32_16x16x32_bf16 v[232:235], a[140:143], a[12:15], v[232:235]
    v_exp_f32 v240, v240
    v_mfma_f32_16x16x32_bf16 v[232:235], a[136:139], a[8:11], v[232:235]
    v_exp_f32 v241, v241
    v_mfma_f32_16x16x32_bf16 v[232:235], a[132:135], a[4:7], v[232:235]
    buffer_load_dwordx4 v55, s[16:19], s36 offen offset:3072 nt lds
    v_mfma_f32_16x16x32_bf16 v[232:235], a[128:131], a[0:3], v[232:235]
    s_waitcnt lgkmcnt(0)
    v_exp_f32 v242, v242
    v_mfma_f32_16x16x32_bf16 v[160:163], a[96:99], a[0:3], v[16:19]
    ds_read_b128 a[156:159], v39 offset:8448
    v_cvt_pk_bf16_f32 v158, v248, v249
    v_mfma_f32_16x16x32_bf16 v[160:163], a[100:103], a[4:7], v[160:163]
    v_exp_f32 v243, v243
    v_mfma_f32_16x16x32_bf16 v[160:163], a[104:107], a[8:11], v[160:163]
    ds_read_b128 a[152:155], v38 offset:8448
    v_cvt_pk_bf16_f32 v159, v250, v251
    v_mfma_f32_16x16x32_bf16 v[160:163], a[108:111], a[12:15], v[160:163]
    v_exp_f32 v83, v83
    v_mfma_f32_16x16x32_bf16 v[160:163], a[112:115], a[16:19], v[160:163]
    ds_read_b128 a[148:151], v37 offset:8448
    v_cvt_pk_bf16_f32 v150, v240, v241
    v_mfma_f32_16x16x32_bf16 v[160:163], a[116:119], a[20:23], v[160:163]
    v_exp_f32 v232, v232
    v_mfma_f32_16x16x32_bf16 v[160:163], a[120:123], a[24:27], v[160:163]
    s_add_u32 m0, s29, 16384
    ds_read_b128 a[144:147], v36 offset:8448
    v_cvt_pk_bf16_f32 v151, v242, v243
    v_mfma_f32_16x16x32_bf16 v[160:163], a[124:127], a[28:31], v[160:163]
    s_mov_b32 s36, 180224
    v_exp_f32 v233, v233
    v_mfma_f32_16x16x32_bf16 v[168:171], a[124:127], a[60:63], v[20:23]
    ds_read_b128 a[140:143], v39 offset:8192
    v_cvt_pk_bf16_f32 v142, v232, v233
    v_mfma_f32_16x16x32_bf16 v[168:171], a[120:123], a[56:59], v[168:171]
    v_exp_f32 v234, v234
    v_mfma_f32_16x16x32_bf16 v[168:171], a[116:119], a[52:55], v[168:171]
    ds_read_b128 a[136:139], v38 offset:8192
    v_sub_f32 v84, v84, v246
    v_mfma_f32_16x16x32_bf16 v[168:171], a[112:115], a[48:51], v[168:171]
    buffer_load_dwordx4 v52, s[16:19], s36 offen offset:0 nt lds
    v_mfma_f32_16x16x32_bf16 v[168:171], a[108:111], a[44:47], v[168:171]
    ds_read_b128 a[132:135], v37 offset:8192
    v_sub_f32 v85, v85, v246
    v_mfma_f32_16x16x32_bf16 v[168:171], a[104:107], a[40:43], v[168:171]
    v_exp_f32 v235, v235
    v_mfma_f32_16x16x32_bf16 v[168:171], a[100:103], a[36:39], v[168:171]
    ds_read_b128 a[128:131], v36 offset:8192
    v_cvt_pk_bf16_f32 v143, v234, v235
    v_mfma_f32_16x16x32_bf16 v[168:171], a[96:99], a[32:35], v[168:171]
    v_exp_f32 v160, v160
    v_mfma_f32_16x16x32_bf16 v[176:179], a[96:99], a[64:67], v[24:27]
    v_exp_f32 v161, v161
    v_mfma_f32_16x16x32_bf16 v[176:179], a[100:103], a[68:71], v[176:179]
    v_exp_f32 v162, v162
    v_mfma_f32_16x16x32_bf16 v[176:179], a[104:107], a[72:75], v[176:179]
    v_exp_f32 v163, v163
    v_mfma_f32_16x16x32_bf16 v[176:179], a[108:111], a[76:79], v[176:179]
    v_exp_f32 v220, v220
    v_mfma_f32_16x16x32_bf16 v[176:179], a[112:115], a[80:83], v[176:179]
    v_exp_f32 v168, v168
    v_mfma_f32_16x16x32_bf16 v[176:179], a[116:119], a[84:87], v[176:179]
    v_exp_f32 v169, v169
    v_mfma_f32_16x16x32_bf16 v[176:179], a[120:123], a[88:91], v[176:179]
    buffer_load_dwordx4 v53, s[16:19], s36 offen offset:1024 nt lds
    v_mfma_f32_16x16x32_bf16 v[176:179], a[124:127], a[92:95], v[176:179]
    s_waitcnt vmcnt(6) lgkmcnt(0)
    v_exp_f32 v170, v170
    v_mfma_f32_16x16x32_bf16 v[12:15], a[156:159], a[92:95], v[24:27]
    s_barrier
    ds_read_b128 a[96:99], v36 offset:16384
    v_cvt_pk_bf16_f32 v160, v160, v161
    v_mfma_f32_16x16x32_bf16 v[12:15], a[152:155], a[88:91], v[12:15]
    v_exp_f32 v171, v171
    v_mfma_f32_16x16x32_bf16 v[12:15], a[148:151], a[84:87], v[12:15]
    ds_read_b128 a[100:103], v37 offset:16384
    v_cvt_pk_bf16_f32 v161, v162, v163
    v_mfma_f32_16x16x32_bf16 v[12:15], a[144:147], a[80:83], v[12:15]
    v_exp_f32 v221, v221
    v_mfma_f32_16x16x32_bf16 v[12:15], a[140:143], a[76:79], v[12:15]
    ds_read_b128 a[104:107], v38 offset:16384
    v_cvt_pk_bf16_f32 v168, v168, v169
    v_mfma_f32_16x16x32_bf16 v[12:15], a[136:139], a[72:75], v[12:15]
    v_exp_f32 v176, v176
    v_mfma_f32_16x16x32_bf16 v[12:15], a[132:135], a[68:71], v[12:15]
    ds_read_b128 a[108:111], v39 offset:16384
    v_cvt_pk_bf16_f32 v169, v170, v171
    v_mfma_f32_16x16x32_bf16 v[12:15], a[128:131], a[64:67], v[12:15]
    v_exp_f32 v177, v177
    v_mfma_f32_16x16x32_bf16 v[8:11], a[128:131], a[32:35], v[20:23]
    ds_read_b128 a[112:115], v36 offset:16640
    v_cvt_pk_bf16_f32 v176, v176, v177
    v_mfma_f32_16x16x32_bf16 v[8:11], a[132:135], a[36:39], v[8:11]
    v_exp_f32 v178, v178
    v_mfma_f32_16x16x32_bf16 v[8:11], a[136:139], a[40:43], v[8:11]
    ds_read_b128 a[116:119], v37 offset:16640
    v_sub_f32 v86, v86, v246
    v_mfma_f32_16x16x32_bf16 v[8:11], a[140:143], a[44:47], v[8:11]
    buffer_load_dwordx4 v54, s[16:19], s36 offen offset:2048 nt lds
    v_mfma_f32_16x16x32_bf16 v[8:11], a[144:147], a[48:51], v[8:11]
    ds_read_b128 a[120:123], v38 offset:16640
    v_sub_f32 v87, v87, v246
    v_mfma_f32_16x16x32_bf16 v[8:11], a[148:151], a[52:55], v[8:11]
    v_exp_f32 v179, v179
    v_mfma_f32_16x16x32_bf16 v[8:11], a[152:155], a[56:59], v[8:11]
    ds_read_b128 a[124:127], v39 offset:16640
    v_cvt_pk_bf16_f32 v177, v178, v179
    v_mfma_f32_16x16x32_bf16 v[8:11], a[156:159], a[60:63], v[8:11]
    v_exp_f32 v12, v12
    v_mfma_f32_16x16x32_bf16 v[4:7], a[156:159], a[28:31], v[16:19]
    v_exp_f32 v13, v13
    v_mfma_f32_16x16x32_bf16 v[4:7], a[152:155], a[24:27], v[4:7]
    v_exp_f32 v14, v14
    v_mfma_f32_16x16x32_bf16 v[4:7], a[148:151], a[20:23], v[4:7]
    v_exp_f32 v15, v15
    v_mfma_f32_16x16x32_bf16 v[4:7], a[144:147], a[16:19], v[4:7]
    buffer_load_dwordx4 v55, s[16:19], s36 offen offset:3072 nt lds
    v_mfma_f32_16x16x32_bf16 v[4:7], a[140:143], a[12:15], v[4:7]
    v_exp_f32 v8, v8
    v_mfma_f32_16x16x32_bf16 v[4:7], a[136:139], a[8:11], v[4:7]
    v_exp_f32 v9, v9
    v_mfma_f32_16x16x32_bf16 v[4:7], a[132:135], a[4:7], v[4:7]
    v_exp_f32 v10, v10
    v_mfma_f32_16x16x32_bf16 v[4:7], a[128:131], a[0:3], v[4:7]
    s_waitcnt lgkmcnt(0)
    v_exp_f32 v11, v11
    v_mfma_f32_16x16x32_bf16 v[164:167], a[96:99], a[0:3], v[16:19]
    ds_read_b128 a[156:159], v39 offset:24832
    v_cvt_pk_bf16_f32 v178, v12, v13
    v_mfma_f32_16x16x32_bf16 v[164:167], a[100:103], a[4:7], v[164:167]
    s_add_u32 m0, s29, 32768
    v_exp_f32 v222, v222
    v_mfma_f32_16x16x32_bf16 v[164:167], a[104:107], a[8:11], v[164:167]
    s_mov_b32 s36, 196608
    ds_read_b128 a[152:155], v38 offset:24832
    v_cvt_pk_bf16_f32 v179, v14, v15
    v_mfma_f32_16x16x32_bf16 v[164:167], a[108:111], a[12:15], v[164:167]
    v_exp_f32 v223, v223
    v_mfma_f32_16x16x32_bf16 v[164:167], a[112:115], a[16:19], v[164:167]
    ds_read_b128 a[148:151], v37 offset:24832
    v_cvt_pk_bf16_f32 v170, v8, v9
    v_mfma_f32_16x16x32_bf16 v[164:167], a[116:119], a[20:23], v[164:167]
    buffer_load_dwordx4 v52, s[16:19], s36 offen offset:0 nt lds
    v_mfma_f32_16x16x32_bf16 v[164:167], a[120:123], a[24:27], v[164:167]
    ds_read_b128 a[144:147], v36 offset:24832
    v_cvt_pk_bf16_f32 v171, v10, v11
    v_mfma_f32_16x16x32_bf16 v[164:167], a[124:127], a[28:31], v[164:167]
    v_exp_f32 v4, v4
    v_mfma_f32_16x16x32_bf16 v[172:175], a[124:127], a[60:63], v[20:23]
    ds_read_b128 a[140:143], v39 offset:24576
    v_sub_f32 v228, v228, v246
    v_mfma_f32_16x16x32_bf16 v[172:175], a[120:123], a[56:59], v[172:175]
    v_exp_f32 v5, v5
    v_mfma_f32_16x16x32_bf16 v[172:175], a[116:119], a[52:55], v[172:175]
    ds_read_b128 a[136:139], v38 offset:24576
    v_cvt_pk_bf16_f32 v162, v4, v5
    v_mfma_f32_16x16x32_bf16 v[172:175], a[112:115], a[48:51], v[172:175]
    v_exp_f32 v6, v6
    v_mfma_f32_16x16x32_bf16 v[172:175], a[108:111], a[44:47], v[172:175]
    ds_read_b128 a[132:135], v37 offset:24576
    v_sub_f32 v229, v229, v246
    v_mfma_f32_16x16x32_bf16 v[172:175], a[104:107], a[40:43], v[172:175]
    v_exp_f32 v7, v7
    v_mfma_f32_16x16x32_bf16 v[172:175], a[100:103], a[36:39], v[172:175]
    ds_read_b128 a[128:131], v36 offset:24576
    v_cvt_pk_bf16_f32 v163, v6, v7
    v_mfma_f32_16x16x32_bf16 v[172:175], a[96:99], a[32:35], v[172:175]
    buffer_load_dwordx4 v53, s[16:19], s36 offen offset:1024 nt lds
    v_mfma_f32_16x16x32_bf16 v[180:183], a[96:99], a[64:67], v[24:27]
    v_exp_f32 v164, v164
    v_mfma_f32_16x16x32_bf16 v[180:183], a[100:103], a[68:71], v[180:183]
L_pad2:
    s_cbranch_execz L_pad6
    v_exp_f32 v165, v165
    v_mfma_f32_16x16x32_bf16 v[180:183], a[104:107], a[72:75], v[180:183]
    v_exp_f32 v166, v166
    v_mfma_f32_16x16x32_bf16 v[180:183], a[108:111], a[76:79], v[180:183]
    v_exp_f32 v167, v167
    v_mfma_f32_16x16x32_bf16 v[180:183], a[112:115], a[80:83], v[180:183]
    v_exp_f32 v172, v172
    v_mfma_f32_16x16x32_bf16 v[180:183], a[116:119], a[84:87], v[180:183]
    v_exp_f32 v173, v173
    v_mfma_f32_16x16x32_bf16 v[180:183], a[120:123], a[88:91], v[180:183]
    v_exp_f32 v174, v174
    v_mfma_f32_16x16x32_bf16 v[180:183], a[124:127], a[92:95], v[180:183]
    s_waitcnt vmcnt(6) lgkmcnt(0)
    v_exp_f32 v175, v175
    v_mfma_f32_16x16x32_bf16 v[248:251], a[156:159], a[92:95], v[24:27]
    s_barrier
    ds_read_b128 a[96:99], v28 offset:0
    v_cvt_pk_bf16_f32 v164, v164, v165
    v_mfma_f32_16x16x32_bf16 v[248:251], a[152:155], a[88:91], v[248:251]
    buffer_load_dwordx4 v54, s[16:19], s36 offen offset:2048 nt lds
    v_mfma_f32_16x16x32_bf16 v[248:251], a[148:151], a[84:87], v[248:251]
    ds_read_b128 a[100:103], v29 offset:0
    v_cvt_pk_bf16_f32 v165, v166, v167
    v_mfma_f32_16x16x32_bf16 v[248:251], a[144:147], a[80:83], v[248:251]
    v_exp_f32 v84, v84
    v_mfma_f32_16x16x32_bf16 v[248:251], a[140:143], a[76:79], v[248:251]
    ds_read_b128 a[104:107], v30 offset:0
    v_cvt_pk_bf16_f32 v172, v172, v173
    v_mfma_f32_16x16x32_bf16 v[248:251], a[136:139], a[72:75], v[248:251]
    v_exp_f32 v180, v180
    v_mfma_f32_16x16x32_bf16 v[248:251], a[132:135], a[68:71], v[248:251]
    ds_read_b128 a[108:111], v31 offset:0
    v_cvt_pk_bf16_f32 v173, v174, v175
    v_mfma_f32_16x16x32_bf16 v[248:251], a[128:131], a[64:67], v[248:251]
    v_exp_f32 v181, v181
    v_mfma_f32_16x16x32_bf16 v[240:243], a[128:131], a[32:35], v[20:23]
    ds_read_b128 a[112:115], v28 offset:256
    v_cvt_pk_bf16_f32 v180, v180, v181
    v_mfma_f32_16x16x32_bf16 v[240:243], a[132:135], a[36:39], v[240:243]
    buffer_load_dwordx4 v55, s[16:19], s36 offen offset:3072 nt lds
    v_mfma_f32_16x16x32_bf16 v[240:243], a[136:139], a[40:43], v[240:243]
    ds_read_b128 a[116:119], v29 offset:256
    v_sub_f32 v230, v230, v246
    v_mfma_f32_16x16x32_bf16 v[240:243], a[140:143], a[44:47], v[240:243]
    v_exp_f32 v182, v182
    v_mfma_f32_16x16x32_bf16 v[240:243], a[144:147], a[48:51], v[240:243]
    ds_read_b128 a[120:123], v30 offset:256
    v_sub_f32 v231, v231, v246
    v_mfma_f32_16x16x32_bf16 v[240:243], a[148:151], a[52:55], v[240:243]
    v_exp_f32 v183, v183
    v_mfma_f32_16x16x32_bf16 v[240:243], a[152:155], a[56:59], v[240:243]
    ds_read_b128 a[124:127], v31 offset:256
    v_cvt_pk_bf16_f32 v181, v182, v183
    v_mfma_f32_16x16x32_bf16 v[240:243], a[156:159], a[60:63], v[240:243]
    s_add_u32 m0, s29, 49152
    v_exp_f32 v248, v248
    v_mfma_f32_16x16x32_bf16 v[232:235], a[156:159], a[28:31], v[16:19]
    s_mov_b32 s36, 212992
    v_exp_f32 v249, v249
    v_mfma_f32_16x16x32_bf16 v[232:235], a[152:155], a[24:27], v[232:235]
    v_exp_f32 v250, v250
    v_mfma_f32_16x16x32_bf16 v[232:235], a[148:151], a[20:23], v[232:235]
    v_exp_f32 v251, v251
    v_mfma_f32_16x16x32_bf16 v[232:235], a[144:147], a[16:19], v[232:235]
    buffer_load_dwordx4 v52, s[16:19], s36 offen offset:0 nt lds
    v_mfma_f32_16x16x32_bf16 v[232:235], a[140:143], a[12:15], v[232:235]
    v_exp_f32 v240, v240
    v_mfma_f32_16x16x32_bf16 v[232:235], a[136:139], a[8:11], v[232:235]
    v_exp_f32 v241, v241
    v_mfma_f32_16x16x32_bf16 v[232:235], a[132:135], a[4:7], v[232:235]
    v_exp_f32 v242, v242
    v_mfma_f32_16x16x32_bf16 v[232:235], a[128:131], a[0:3], v[232:235]
    s_waitcnt lgkmcnt(0)
    v_exp_f32 v243, v243
    v_mfma_f32_16x16x32_bf16 v[184:187], a[96:99], a[0:3], v[16:19]
    ds_read_b128 a[156:159], v31 offset:8448
    v_cvt_pk_bf16_f32 v182, v248, v249
    v_mfma_f32_16x16x32_bf16 v[184:187], a[100:103], a[4:7], v[184:187]
    v_exp_f32 v85, v85
    v_mfma_f32_16x16x32_bf16 v[184:187], a[104:107], a[8:11], v[184:187]
    ds_read_b128 a[152:155], v30 offset:8448
    v_cvt_pk_bf16_f32 v183, v250, v251
    v_mfma_f32_16x16x32_bf16 v[184:187], a[108:111], a[12:15], v[184:187]
    v_exp_f32 v86, v86
    v_mfma_f32_16x16x32_bf16 v[184:187], a[112:115], a[16:19], v[184:187]
    ds_read_b128 a[148:151], v29 offset:8448
    v_cvt_pk_bf16_f32 v174, v240, v241
    v_mfma_f32_16x16x32_bf16 v[184:187], a[116:119], a[20:23], v[184:187]
    buffer_load_dwordx4 v53, s[16:19], s36 offen offset:1024 nt lds
    v_mfma_f32_16x16x32_bf16 v[184:187], a[120:123], a[24:27], v[184:187]
    ds_read_b128 a[144:147], v28 offset:8448
    v_cvt_pk_bf16_f32 v175, v242, v243
    v_mfma_f32_16x16x32_bf16 v[184:187], a[124:127], a[28:31], v[184:187]
    v_exp_f32 v232, v232
    v_mfma_f32_16x16x32_bf16 v[192:195], a[124:127], a[60:63], v[20:23]
    ds_read_b128 a[140:143], v31 offset:8192
    v_cvt_pk_bf16_f32 v80, v80, v81
    v_mfma_f32_16x16x32_bf16 v[192:195], a[120:123], a[56:59], v[192:195]
    v_exp_f32 v233, v233
    v_mfma_f32_16x16x32_bf16 v[192:195], a[116:119], a[52:55], v[192:195]
    ds_read_b128 a[136:139], v30 offset:8192
    v_cvt_pk_bf16_f32 v166, v232, v233
    v_mfma_f32_16x16x32_bf16 v[192:195], a[112:115], a[48:51], v[192:195]
    v_exp_f32 v234, v234
    v_mfma_f32_16x16x32_bf16 v[192:195], a[108:111], a[44:47], v[192:195]
    ds_read_b128 a[132:135], v29 offset:8192
    v_cvt_pk_bf16_f32 v81, v82, v83
    v_mfma_f32_16x16x32_bf16 v[192:195], a[104:107], a[40:43], v[192:195]
    v_exp_f32 v235, v235
    v_mfma_f32_16x16x32_bf16 v[192:195], a[100:103], a[36:39], v[192:195]
    ds_read_b128 a[128:131], v28 offset:8192
    v_cvt_pk_bf16_f32 v167, v234, v235
    v_mfma_f32_16x16x32_bf16 v[192:195], a[96:99], a[32:35], v[192:195]
    buffer_load_dwordx4 v54, s[16:19], s36 offen offset:2048 nt lds
    v_mfma_f32_16x16x32_bf16 v[200:203], a[96:99], a[64:67], v[24:27]
    v_exp_f32 v184, v184
    v_mfma_f32_16x16x32_bf16 v[200:203], a[100:103], a[68:71], v[200:203]
    v_exp_f32 v185, v185
    v_mfma_f32_16x16x32_bf16 v[200:203], a[104:107], a[72:75], v[200:203]
    v_exp_f32 v186, v186
    v_mfma_f32_16x16x32_bf16 v[200:203], a[108:111], a[76:79], v[200:203]
    v_exp_f32 v187, v187
    v_mfma_f32_16x16x32_bf16 v[200:203], a[112:115], a[80:83], v[200:203]
    v_exp_f32 v192, v192
    v_mfma_f32_16x16x32_bf16 v[200:203], a[116:119], a[84:87], v[200:203]
    v_exp_f32 v193, v193
    v_mfma_f32_16x16x32_bf16 v[200:203], a[120:123], a[88:91], v[200:203]
    v_exp_f32 v194, v194
    v_mfma_f32_16x16x32_bf16 v[200:203], a[124:127], a[92:95], v[200:203]
    s_waitcnt vmcnt(7) lgkmcnt(0)
    buffer_load_dwordx4 v55, s[16:19], s36 offen offset:3072 nt lds
    v_mfma_f32_16x16x32_bf16 v[12:15], a[156:159], a[92:95], v[24:27]
    s_barrier
    ds_read_b128 a[96:99], v28 offset:16384
    v_cvt_pk_bf16_f32 v184, v184, v185
    v_mfma_f32_16x16x32_bf16 v[12:15], a[152:155], a[88:91], v[12:15]
    v_exp_f32 v195, v195
    v_mfma_f32_16x16x32_bf16 v[12:15], a[148:151], a[84:87], v[12:15]
    ds_read_b128 a[100:103], v29 offset:16384
    v_cvt_pk_bf16_f32 v185, v186, v187
    v_mfma_f32_16x16x32_bf16 v[12:15], a[144:147], a[80:83], v[12:15]
    v_exp_f32 v87, v87
    v_mfma_f32_16x16x32_bf16 v[12:15], a[140:143], a[76:79], v[12:15]
    ds_read_b128 a[104:107], v30 offset:16384
    v_cvt_pk_bf16_f32 v192, v192, v193
    v_mfma_f32_16x16x32_bf16 v[12:15], a[136:139], a[72:75], v[12:15]
    s_add_u32 m0, s29, 65536
    v_exp_f32 v200, v200
    v_mfma_f32_16x16x32_bf16 v[12:15], a[132:135], a[68:71], v[12:15]
    s_mov_b32 s36, 229376
    ds_read_b128 a[108:111], v31 offset:16384
    v_cvt_pk_bf16_f32 v193, v194, v195
    v_mfma_f32_16x16x32_bf16 v[12:15], a[128:131], a[64:67], v[12:15]
    v_exp_f32 v201, v201
    v_mfma_f32_16x16x32_bf16 v[8:11], a[128:131], a[32:35], v[20:23]
    ds_read_b128 a[112:115], v28 offset:16640
    v_cvt_pk_bf16_f32 v200, v200, v201
    v_mfma_f32_16x16x32_bf16 v[8:11], a[132:135], a[36:39], v[8:11]
    buffer_load_dwordx4 v52, s[16:19], s36 offen offset:0 nt lds
    v_mfma_f32_16x16x32_bf16 v[8:11], a[136:139], a[40:43], v[8:11]
    ds_read_b128 a[116:119], v29 offset:16640
    v_cvt_pk_bf16_f32 v82, v220, v221
    v_mfma_f32_16x16x32_bf16 v[8:11], a[140:143], a[44:47], v[8:11]
    v_exp_f32 v202, v202
    v_mfma_f32_16x16x32_bf16 v[8:11], a[144:147], a[48:51], v[8:11]
    ds_read_b128 a[120:123], v30 offset:16640
    v_cvt_pk_bf16_f32 v83, v222, v223
    v_mfma_f32_16x16x32_bf16 v[8:11], a[148:151], a[52:55], v[8:11]
    v_exp_f32 v203, v203
    v_mfma_f32_16x16x32_bf16 v[8:11], a[152:155], a[56:59], v[8:11]
    ds_read_b128 a[124:127], v31 offset:16640
    v_cvt_pk_bf16_f32 v201, v202, v203
    v_mfma_f32_16x16x32_bf16 v[8:11], a[156:159], a[60:63], v[8:11]
    v_exp_f32 v12, v12
    v_mfma_f32_16x16x32_bf16 v[4:7], a[156:159], a[28:31], v[16:19]
    v_exp_f32 v13, v13
    v_mfma_f32_16x16x32_bf16 v[4:7], a[152:155], a[24:27], v[4:7]
    v_exp_f32 v14, v14
    v_mfma_f32_16x16x32_bf16 v[4:7], a[148:151], a[20:23], v[4:7]
    buffer_load_dwordx4 v53, s[16:19], s36 offen offset:1024 nt lds
    v_mfma_f32_16x16x32_bf16 v[4:7], a[144:147], a[16:19], v[4:7]
    v_exp_f32 v15, v15
    v_mfma_f32_16x16x32_bf16 v[4:7], a[140:143], a[12:15], v[4:7]
    v_exp_f32 v8, v8
    v_mfma_f32_16x16x32_bf16 v[4:7], a[136:139], a[8:11], v[4:7]
    v_exp_f32 v9, v9
    v_mfma_f32_16x16x32_bf16 v[4:7], a[132:135], a[4:7], v[4:7]
    v_exp_f32 v10, v10
    v_mfma_f32_16x16x32_bf16 v[4:7], a[128:131], a[0:3], v[4:7]
    s_waitcnt lgkmcnt(0)
    v_exp_f32 v11, v11
    v_mfma_f32_16x16x32_bf16 v[188:191], a[96:99], a[0:3], v[16:19]
    ds_read_b128 a[156:159], v31 offset:24832
    v_cvt_pk_bf16_f32 v202, v12, v13
    v_mfma_f32_16x16x32_bf16 v[188:191], a[100:103], a[4:7], v[188:191]
    v_exp_f32 v228, v228
    v_mfma_f32_16x16x32_bf16 v[188:191], a[104:107], a[8:11], v[188:191]
    ds_read_b128 a[152:155], v30 offset:24832
    v_cvt_pk_bf16_f32 v203, v14, v15
    v_mfma_f32_16x16x32_bf16 v[188:191], a[108:111], a[12:15], v[188:191]
    v_exp_f32 v229, v229
    v_mfma_f32_16x16x32_bf16 v[188:191], a[112:115], a[16:19], v[188:191]
    ds_read_b128 a[148:151], v29 offset:24832
    v_cvt_pk_bf16_f32 v194, v8, v9
    v_mfma_f32_16x16x32_bf16 v[188:191], a[116:119], a[20:23], v[188:191]
    buffer_load_dwordx4 v54, s[16:19], s36 offen offset:2048 nt lds
    v_mfma_f32_16x16x32_bf16 v[188:191], a[120:123], a[24:27], v[188:191]
    ds_read_b128 a[144:147], v28 offset:24832
    v_cvt_pk_bf16_f32 v195, v10, v11
    v_mfma_f32_16x16x32_bf16 v[188:191], a[124:127], a[28:31], v[188:191]
    v_exp_f32 v4, v4
    v_mfma_f32_16x16x32_bf16 v[196:199], a[124:127], a[60:63], v[20:23]
    ds_read_b128 a[140:143], v31 offset:24576
    v_cvt_pk_bf16_f32 v84, v84, v85
    v_mfma_f32_16x16x32_bf16 v[196:199], a[120:123], a[56:59], v[196:199]
    v_exp_f32 v5, v5
    v_mfma_f32_16x16x32_bf16 v[196:199], a[116:119], a[52:55], v[196:199]
    ds_read_b128 a[136:139], v30 offset:24576
    v_cvt_pk_bf16_f32 v186, v4, v5
    v_mfma_f32_16x16x32_bf16 v[196:199], a[112:115], a[48:51], v[196:199]
    v_exp_f32 v6, v6
    v_mfma_f32_16x16x32_bf16 v[196:199], a[108:111], a[44:47], v[196:199]
    ds_read_b128 a[132:135], v29 offset:24576
    v_cvt_pk_bf16_f32 v85, v86, v87
    v_mfma_f32_16x16x32_bf16 v[196:199], a[104:107], a[40:43], v[196:199]
    buffer_load_dwordx4 v55, s[16:19], s36 offen offset:3072 nt lds
    v_mfma_f32_16x16x32_bf16 v[196:199], a[100:103], a[36:39], v[196:199]
    ds_read_b128 a[128:131], v28 offset:24576
    v_cvt_pk_bf16_f32 v86, v228, v229
    v_mfma_f32_16x16x32_bf16 v[196:199], a[96:99], a[32:35], v[196:199]
    v_exp_f32 v7, v7
    v_mfma_f32_16x16x32_bf16 v[204:207], a[96:99], a[64:67], v[24:27]
    v_exp_f32 v188, v188
    v_mfma_f32_16x16x32_bf16 v[204:207], a[100:103], a[68:71], v[204:207]
    v_exp_f32 v189, v189
    v_mfma_f32_16x16x32_bf16 v[204:207], a[104:107], a[72:75], v[204:207]
    v_exp_f32 v190, v190
    v_mfma_f32_16x16x32_bf16 v[204:207], a[108:111], a[76:79], v[204:207]
    s_add_u32 m0, s29, 81920
    v_exp_f32 v191, v191
    v_mfma_f32_16x16x32_bf16 v[204:207], a[112:115], a[80:83], v[204:207]
    s_mov_b32 s36, 245760
    v_exp_f32 v196, v196
    v_mfma_f32_16x16x32_bf16 v[204:207], a[116:119], a[84:87], v[204:207]
    v_exp_f32 v197, v197
    v_mfma_f32_16x16x32_bf16 v[204:207], a[120:123], a[88:91], v[204:207]
    v_exp_f32 v198, v198
    v_mfma_f32_16x16x32_bf16 v[204:207], a[124:127], a[92:95], v[204:207]
    s_waitcnt vmcnt(8) lgkmcnt(0)
    buffer_load_dwordx4 v52, s[16:19], s36 offen offset:0 nt lds
    v_mfma_f32_16x16x32_bf16 v[248:251], a[156:159], a[92:95], v[24:27]
    s_barrier
    ds_read_b128 a[96:99], v28 offset:32768
    v_cvt_pk_bf16_f32 v187, v6, v7
    v_mfma_f32_16x16x32_bf16 v[248:251], a[152:155], a[88:91], v[248:251]
    v_exp_f32 v199, v199
    v_mfma_f32_16x16x32_bf16 v[248:251], a[148:151], a[84:87], v[248:251]
    ds_read_b128 a[100:103], v29 offset:32768
    v_cvt_pk_bf16_f32 v188, v188, v189
    v_mfma_f32_16x16x32_bf16 v[248:251], a[144:147], a[80:83], v[248:251]
    v_exp_f32 v230, v230
    v_mfma_f32_16x16x32_bf16 v[248:251], a[140:143], a[76:79], v[248:251]
    ds_read_b128 a[104:107], v30 offset:32768
    v_cvt_pk_bf16_f32 v189, v190, v191
    v_mfma_f32_16x16x32_bf16 v[248:251], a[136:139], a[72:75], v[248:251]
    v_exp_f32 v204, v204
    v_mfma_f32_16x16x32_bf16 v[248:251], a[132:135], a[68:71], v[248:251]
    ds_read_b128 a[108:111], v31 offset:32768
    v_cvt_pk_bf16_f32 v196, v196, v197
    v_mfma_f32_16x16x32_bf16 v[248:251], a[128:131], a[64:67], v[248:251]
    v_exp_f32 v205, v205
    v_mfma_f32_16x16x32_bf16 v[240:243], a[128:131], a[32:35], v[20:23]
    ds_read_b128 a[112:115], v28 offset:33024
    v_cvt_pk_bf16_f32 v197, v198, v199
    v_mfma_f32_16x16x32_bf16 v[240:243], a[132:135], a[36:39], v[240:243]
    buffer_load_dwordx4 v53, s[16:19], s36 offen offset:1024 nt lds
    v_mfma_f32_16x16x32_bf16 v[240:243], a[136:139], a[40:43], v[240:243]
    ds_read_b128 a[116:119], v29 offset:33024
    v_cvt_pk_bf16_f32 v204, v204, v205
    v_mfma_f32_16x16x32_bf16 v[240:243], a[140:143], a[44:47], v[240:243]
    v_exp_f32 v206, v206
    v_mfma_f32_16x16x32_bf16 v[240:243], a[144:147], a[48:51], v[240:243]
    ds_read_b128 a[120:123], v30 offset:33024
    v_mfma_f32_16x16x32_bf16 v[240:243], a[148:151], a[52:55], v[240:243]
    v_exp_f32 v207, v207
    v_mfma_f32_16x16x32_bf16 v[240:243], a[152:155], a[56:59], v[240:243]
    ds_read_b128 a[124:127], v31 offset:33024
    v_cvt_pk_bf16_f32 v205, v206, v207
    v_mfma_f32_16x16x32_bf16 v[240:243], a[156:159], a[60:63], v[240:243]
    v_exp_f32 v248, v248
    v_mfma_f32_16x16x32_bf16 v[232:235], a[156:159], a[28:31], v[16:19]
    v_exp_f32 v249, v249
    v_mfma_f32_16x16x32_bf16 v[232:235], a[152:155], a[24:27], v[232:235]
    v_exp_f32 v250, v250
    v_mfma_f32_16x16x32_bf16 v[232:235], a[148:151], a[20:23], v[232:235]
    buffer_load_dwordx4 v54, s[16:19], s36 offen offset:2048 nt lds
    v_mfma_f32_16x16x32_bf16 v[232:235], a[144:147], a[16:19], v[232:235]
    v_exp_f32 v251, v251
    v_mfma_f32_16x16x32_bf16 v[232:235], a[140:143], a[12:15], v[232:235]
    v_exp_f32 v240, v240
    v_mfma_f32_16x16x32_bf16 v[232:235], a[136:139], a[8:11], v[232:235]
    v_exp_f32 v241, v241
    v_mfma_f32_16x16x32_bf16 v[232:235], a[132:135], a[4:7], v[232:235]
    v_exp_f32 v242, v242
    v_mfma_f32_16x16x32_bf16 v[232:235], a[128:131], a[0:3], v[232:235]
    s_waitcnt lgkmcnt(0)
    v_exp_f32 v243, v243
    v_mfma_f32_16x16x32_bf16 v[208:211], a[96:99], a[0:3], v[16:19]
    ds_read_b128 a[156:159], v31 offset:41216
    v_cvt_pk_bf16_f32 v206, v248, v249
    v_mfma_f32_16x16x32_bf16 v[208:211], a[100:103], a[4:7], v[208:211]
    v_exp_f32 v231, v231
    v_mfma_f32_16x16x32_bf16 v[208:211], a[104:107], a[8:11], v[208:211]
    ds_read_b128 a[152:155], v30 offset:41216
    v_cvt_pk_bf16_f32 v207, v250, v251
    v_mfma_f32_16x16x32_bf16 v[208:211], a[108:111], a[12:15], v[208:211]
    buffer_load_dwordx4 v55, s[16:19], s36 offen offset:3072 nt lds
    v_mfma_f32_16x16x32_bf16 v[208:211], a[112:115], a[16:19], v[208:211]
    ds_read_b128 a[148:151], v29 offset:41216
    v_cvt_pk_bf16_f32 v198, v240, v241
    v_mfma_f32_16x16x32_bf16 v[208:211], a[116:119], a[20:23], v[208:211]
    v_exp_f32 v232, v232
    v_mfma_f32_16x16x32_bf16 v[208:211], a[120:123], a[24:27], v[208:211]
    ds_read_b128 a[144:147], v28 offset:41216
    v_cvt_pk_bf16_f32 v199, v242, v243
    v_mfma_f32_16x16x32_bf16 v[208:211], a[124:127], a[28:31], v[208:211]
    v_exp_f32 v233, v233
    v_mfma_f32_16x16x32_bf16 v[216:219], a[124:127], a[60:63], v[20:23]
    ds_read_b128 a[140:143], v31 offset:40960
    v_cvt_pk_bf16_f32 v190, v232, v233
    v_mfma_f32_16x16x32_bf16 v[216:219], a[120:123], a[56:59], v[216:219]
    s_add_u32 m0, s29, 98304
    v_exp_f32 v234, v234
    v_mfma_f32_16x16x32_bf16 v[216:219], a[116:119], a[52:55], v[216:219]
    s_xor_b32 s36, s68, 0
    ds_read_b128 a[136:139], v30 offset:40960
    v_cvt_pk_bf16_f32 v87, v230, v231
    v_mfma_f32_16x16x32_bf16 v[216:219], a[112:115], a[48:51], v[216:219]
    v_exp_f32 v235, v235
    v_mfma_f32_16x16x32_bf16 v[216:219], a[108:111], a[44:47], v[216:219]
    ds_read_b128 a[132:135], v29 offset:40960
    v_cvt_pk_bf16_f32 v191, v234, v235
    v_mfma_f32_16x16x32_bf16 v[216:219], a[104:107], a[40:43], v[216:219]
    buffer_load_dwordx4 v56, s[20:23], s36 offen offset:0 nt lds
    v_mfma_f32_16x16x32_bf16 v[216:219], a[100:103], a[36:39], v[216:219]
    ds_read_b128 a[128:131], v28 offset:40960
    v_accvgpr_write_b32 a164, v64
    v_mfma_f32_16x16x32_bf16 v[216:219], a[96:99], a[32:35], v[216:219]
    v_exp_f32 v208, v208
    v_mfma_f32_16x16x32_bf16 v[224:227], a[96:99], a[64:67], v[24:27]
    v_exp_f32 v209, v209
    v_mfma_f32_16x16x32_bf16 v[224:227], a[100:103], a[68:71], v[224:227]
    v_exp_f32 v210, v210
    v_mfma_f32_16x16x32_bf16 v[224:227], a[104:107], a[72:75], v[224:227]
    v_exp_f32 v211, v211
    v_mfma_f32_16x16x32_bf16 v[224:227], a[108:111], a[76:79], v[224:227]
    v_accvgpr_write_b32 a165, v65
    v_mfma_f32_16x16x32_bf16 v[224:227], a[112:115], a[80:83], v[224:227]
    v_exp_f32 v216, v216
    v_mfma_f32_16x16x32_bf16 v[224:227], a[116:119], a[84:87], v[224:227]
    v_exp_f32 v217, v217
    v_mfma_f32_16x16x32_bf16 v[224:227], a[120:123], a[88:91], v[224:227]
    buffer_load_dwordx4 v57, s[20:23], s36 offen offset:1024 nt lds
    v_mfma_f32_16x16x32_bf16 v[224:227], a[124:127], a[92:95], v[224:227]
    s_waitcnt vmcnt(10) lgkmcnt(0)
    v_exp_f32 v218, v218
    v_mfma_f32_16x16x32_bf16 v[12:15], a[156:159], a[92:95], v[24:27]
    s_barrier
    ds_read_b128 a[96:99], v28 offset:49152
    v_cvt_pk_bf16_f32 v208, v208, v209
    v_mfma_f32_16x16x32_bf16 v[12:15], a[152:155], a[88:91], v[12:15]
    v_exp_f32 v219, v219
    v_mfma_f32_16x16x32_bf16 v[12:15], a[148:151], a[84:87], v[12:15]
    ds_read_b128 a[100:103], v29 offset:49152
    v_cvt_pk_bf16_f32 v209, v210, v211
    v_mfma_f32_16x16x32_bf16 v[12:15], a[144:147], a[80:83], v[12:15]
    v_accvgpr_write_b32 a166, v66
    v_mfma_f32_16x16x32_bf16 v[12:15], a[140:143], a[76:79], v[12:15]
    ds_read_b128 a[104:107], v30 offset:49152
    v_cvt_pk_bf16_f32 v216, v216, v217
    v_mfma_f32_16x16x32_bf16 v[12:15], a[136:139], a[72:75], v[12:15]
    v_exp_f32 v224, v224
    v_mfma_f32_16x16x32_bf16 v[12:15], a[132:135], a[68:71], v[12:15]
    ds_read_b128 a[108:111], v31 offset:49152
    v_cvt_pk_bf16_f32 v217, v218, v219
    v_mfma_f32_16x16x32_bf16 v[12:15], a[128:131], a[64:67], v[12:15]
    v_exp_f32 v225, v225
    v_mfma_f32_16x16x32_bf16 v[8:11], a[128:131], a[32:35], v[20:23]
    ds_read_b128 a[112:115], v28 offset:49408
    v_cvt_pk_bf16_f32 v224, v224, v225
    v_mfma_f32_16x16x32_bf16 v[8:11], a[132:135], a[36:39], v[8:11]
    buffer_load_dwordx4 v58, s[20:23], s36 offen offset:2048 nt lds
    v_mfma_f32_16x16x32_bf16 v[8:11], a[136:139], a[40:43], v[8:11]
    ds_read_b128 a[116:119], v29 offset:49408
    v_accvgpr_write_b32 a167, v67
    v_mfma_f32_16x16x32_bf16 v[8:11], a[140:143], a[44:47], v[8:11]
    v_exp_f32 v226, v226
    v_mfma_f32_16x16x32_bf16 v[8:11], a[144:147], a[48:51], v[8:11]
    ds_read_b128 a[120:123], v30 offset:49408
    v_accvgpr_write_b32 a172, v72
    v_mfma_f32_16x16x32_bf16 v[8:11], a[148:151], a[52:55], v[8:11]
    v_exp_f32 v227, v227
    v_mfma_f32_16x16x32_bf16 v[8:11], a[152:155], a[56:59], v[8:11]
    ds_read_b128 a[124:127], v31 offset:49408
    v_cvt_pk_bf16_f32 v225, v226, v227
    v_mfma_f32_16x16x32_bf16 v[8:11], a[156:159], a[60:63], v[8:11]
    v_exp_f32 v12, v12
    v_mfma_f32_16x16x32_bf16 v[4:7], a[156:159], a[28:31], v[16:19]
    v_exp_f32 v13, v13
    v_mfma_f32_16x16x32_bf16 v[4:7], a[152:155], a[24:27], v[4:7]
    buffer_load_dwordx4 v59, s[20:23], s36 offen offset:3072 nt lds
    v_mfma_f32_16x16x32_bf16 v[4:7], a[148:151], a[20:23], v[4:7]
    v_exp_f32 v14, v14
    v_mfma_f32_16x16x32_bf16 v[4:7], a[144:147], a[16:19], v[4:7]
    v_exp_f32 v15, v15
    v_mfma_f32_16x16x32_bf16 v[4:7], a[140:143], a[12:15], v[4:7]
    v_exp_f32 v8, v8
    v_mfma_f32_16x16x32_bf16 v[4:7], a[136:139], a[8:11], v[4:7]
    v_exp_f32 v9, v9
    v_mfma_f32_16x16x32_bf16 v[4:7], a[132:135], a[4:7], v[4:7]
    s_waitcnt lgkmcnt(0)
    v_exp_f32 v10, v10
    v_mfma_f32_16x16x32_bf16 v[4:7], a[128:131], a[0:3], v[4:7]
    s_add_u32 m0, s29, 114688
    v_exp_f32 v11, v11
    v_mfma_f32_16x16x32_bf16 v[212:215], a[96:99], a[0:3], v[16:19]
    s_xor_b32 s36, s68, 65536
    ds_read_b128 a[156:159], v31 offset:57600
    v_cvt_pk_bf16_f32 v226, v12, v13
    v_mfma_f32_16x16x32_bf16 v[212:215], a[100:103], a[4:7], v[212:215]
    v_accvgpr_write_b32 a173, v73
    v_mfma_f32_16x16x32_bf16 v[212:215], a[104:107], a[8:11], v[212:215]
    ds_read_b128 a[152:155], v30 offset:57600
    v_cvt_pk_bf16_f32 v227, v14, v15
    v_mfma_f32_16x16x32_bf16 v[212:215], a[108:111], a[12:15], v[212:215]
    buffer_load_dwordx4 v56, s[20:23], s36 offen offset:0 nt lds
    v_mfma_f32_16x16x32_bf16 v[212:215], a[112:115], a[16:19], v[212:215]
    ds_read_b128 a[148:151], v29 offset:57600
    v_cvt_pk_bf16_f32 v218, v8, v9
    v_mfma_f32_16x16x32_bf16 v[212:215], a[116:119], a[20:23], v[212:215]
    v_exp_f32 v4, v4
    v_mfma_f32_16x16x32_bf16 v[212:215], a[120:123], a[24:27], v[212:215]
    ds_read_b128 a[144:147], v28 offset:57600
    v_cvt_pk_bf16_f32 v219, v10, v11
    v_mfma_f32_16x16x32_bf16 v[212:215], a[124:127], a[28:31], v[212:215]
    v_exp_f32 v5, v5
    v_mfma_f32_16x16x32_bf16 v[220:223], a[124:127], a[60:63], v[20:23]
    ds_read_b128 a[140:143], v31 offset:57344
    v_cvt_pk_bf16_f32 v210, v4, v5
    v_mfma_f32_16x16x32_bf16 v[220:223], a[120:123], a[56:59], v[220:223]
    v_exp_f32 v6, v6
    v_mfma_f32_16x16x32_bf16 v[220:223], a[116:119], a[52:55], v[220:223]
    ds_read_b128 a[136:139], v30 offset:57344
    v_accvgpr_write_b32 a174, v74
    v_mfma_f32_16x16x32_bf16 v[220:223], a[112:115], a[48:51], v[220:223]
    v_exp_f32 v7, v7
    v_mfma_f32_16x16x32_bf16 v[220:223], a[108:111], a[44:47], v[220:223]
    ds_read_b128 a[132:135], v29 offset:57344
    v_cvt_pk_bf16_f32 v211, v6, v7
    v_mfma_f32_16x16x32_bf16 v[220:223], a[104:107], a[40:43], v[220:223]
    buffer_load_dwordx4 v57, s[20:23], s36 offen offset:1024 nt lds
    v_mfma_f32_16x16x32_bf16 v[220:223], a[100:103], a[36:39], v[220:223]
    ds_read_b128 a[128:131], v28 offset:57344
    v_accvgpr_write_b32 a175, v75
    v_mfma_f32_16x16x32_bf16 v[220:223], a[96:99], a[32:35], v[220:223]
    v_exp_f32 v212, v212
    v_mfma_f32_16x16x32_bf16 v[228:231], a[96:99], a[64:67], v[24:27]
    v_exp_f32 v213, v213
    v_mfma_f32_16x16x32_bf16 v[228:231], a[100:103], a[68:71], v[228:231]
    v_exp_f32 v214, v214
    v_mfma_f32_16x16x32_bf16 v[228:231], a[104:107], a[72:75], v[228:231]
    v_exp_f32 v215, v215
    v_mfma_f32_16x16x32_bf16 v[228:231], a[108:111], a[76:79], v[228:231]
    v_accvgpr_write_b32 a180, v80
    v_mfma_f32_16x16x32_bf16 v[228:231], a[112:115], a[80:83], v[228:231]
    v_exp_f32 v220, v220
    v_mfma_f32_16x16x32_bf16 v[228:231], a[116:119], a[84:87], v[228:231]
    v_exp_f32 v221, v221
    v_mfma_f32_16x16x32_bf16 v[228:231], a[120:123], a[88:91], v[228:231]
    buffer_load_dwordx4 v58, s[20:23], s36 offen offset:2048 nt lds
    v_mfma_f32_16x16x32_bf16 v[228:231], a[124:127], a[92:95], v[228:231]
    s_waitcnt vmcnt(11) lgkmcnt(0)
    v_exp_f32 v222, v222
    v_mfma_f32_16x16x32_bf16 v[12:15], a[156:159], a[92:95], v[24:27]
    s_barrier
    ds_read_b128 a[96:99], v32 offset:0
    v_cvt_pk_bf16_f32 v212, v212, v213
    v_mfma_f32_16x16x32_bf16 v[12:15], a[152:155], a[88:91], v[12:15]
    v_exp_f32 v223, v223
    v_mfma_f32_16x16x32_bf16 v[12:15], a[148:151], a[84:87], v[12:15]
    ds_read_b128 a[100:103], v33 offset:0
    v_cvt_pk_bf16_f32 v213, v214, v215
    v_mfma_f32_16x16x32_bf16 v[12:15], a[144:147], a[80:83], v[12:15]
    v_accvgpr_write_b32 a181, v81
    v_mfma_f32_16x16x32_bf16 v[12:15], a[140:143], a[76:79], v[12:15]
    ds_read_b128 a[104:107], v34 offset:0
    v_cvt_pk_bf16_f32 v220, v220, v221
    v_mfma_f32_16x16x32_bf16 v[12:15], a[136:139], a[72:75], v[12:15]
    v_exp_f32 v228, v228
    v_mfma_f32_16x16x32_bf16 v[12:15], a[132:135], a[68:71], v[12:15]
    ds_read_b128 a[108:111], v35 offset:0
    v_cvt_pk_bf16_f32 v221, v222, v223
    v_mfma_f32_16x16x32_bf16 v[12:15], a[128:131], a[64:67], v[12:15]
    buffer_load_dwordx4 v59, s[20:23], s36 offen offset:3072 nt lds
    v_mfma_f32_16x16x32_bf16 v[8:11], a[128:131], a[32:35], v[20:23]
    ds_read_b128 a[112:115], v32 offset:256
    v_accvgpr_write_b32 a182, v82
    v_mfma_f32_16x16x32_bf16 v[8:11], a[132:135], a[36:39], v[8:11]
    v_exp_f32 v229, v229
    v_mfma_f32_16x16x32_bf16 v[8:11], a[136:139], a[40:43], v[8:11]
    ds_read_b128 a[116:119], v33 offset:256
    v_cvt_pk_bf16_f32 v228, v228, v229
    v_mfma_f32_16x16x32_bf16 v[8:11], a[140:143], a[44:47], v[8:11]
    v_exp_f32 v230, v230
    v_mfma_f32_16x16x32_bf16 v[8:11], a[144:147], a[48:51], v[8:11]
    ds_read_b128 a[120:123], v34 offset:256
    v_accvgpr_write_b32 a183, v83
    v_mfma_f32_16x16x32_bf16 v[8:11], a[148:151], a[52:55], v[8:11]
    s_add_u32 m0, s29, 131072
    v_exp_f32 v231, v231
    v_mfma_f32_16x16x32_bf16 v[8:11], a[152:155], a[56:59], v[8:11]
    s_xor_b32 s36, s68, 131072
    ds_read_b128 a[124:127], v35 offset:256
    v_cvt_pk_bf16_f32 v229, v230, v231
    v_mfma_f32_16x16x32_bf16 v[8:11], a[156:159], a[60:63], v[8:11]
    v_exp_f32 v12, v12
    v_mfma_f32_16x16x32_bf16 v[4:7], a[156:159], a[28:31], v[16:19]
    v_exp_f32 v13, v13
    v_mfma_f32_16x16x32_bf16 v[4:7], a[152:155], a[24:27], v[4:7]
    buffer_load_dwordx4 v56, s[20:23], s36 offen offset:0 nt lds
    v_mfma_f32_16x16x32_bf16 v[4:7], a[148:151], a[20:23], v[4:7]
    v_exp_f32 v14, v14
    v_mfma_f32_16x16x32_bf16 v[4:7], a[144:147], a[16:19], v[4:7]
    v_exp_f32 v15, v15
    v_mfma_f32_16x16x32_bf16 v[4:7], a[140:143], a[12:15], v[4:7]
    v_exp_f32 v8, v8
    v_mfma_f32_16x16x32_bf16 v[4:7], a[136:139], a[8:11], v[4:7]
    v_exp_f32 v9, v9
    v_mfma_f32_16x16x32_bf16 v[4:7], a[132:135], a[4:7], v[4:7]
    v_exp_f32 v10, v10
    v_mfma_f32_16x16x32_bf16 v[4:7], a[128:131], a[0:3], v[4:7]
    s_waitcnt lgkmcnt(0)
    v_exp_f32 v11, v11
    v_mfma_f32_16x16x32_bf16 v[232:235], a[96:99], a[0:3], v[16:19]
    ds_read_b128 a[156:159], v35 offset:8448
    v_cvt_pk_bf16_f32 v230, v12, v13
    v_mfma_f32_16x16x32_bf16 v[232:235], a[100:103], a[4:7], v[232:235]
    v_accvgpr_write_b32 a168, v68
    v_mfma_f32_16x16x32_bf16 v[232:235], a[104:107], a[8:11], v[232:235]
    ds_read_b128 a[152:155], v34 offset:8448
    v_cvt_pk_bf16_f32 v231, v14, v15
    v_mfma_f32_16x16x32_bf16 v[232:235], a[108:111], a[12:15], v[232:235]
    buffer_load_dwordx4 v57, s[20:23], s36 offen offset:1024 nt lds
    v_mfma_f32_16x16x32_bf16 v[232:235], a[112:115], a[16:19], v[232:235]
    ds_read_b128 a[148:151], v33 offset:8448
    v_cvt_pk_bf16_f32 v222, v8, v9
    v_mfma_f32_16x16x32_bf16 v[232:235], a[116:119], a[20:23], v[232:235]
    v_exp_f32 v4, v4
    v_mfma_f32_16x16x32_bf16 v[232:235], a[120:123], a[24:27], v[232:235]
    ds_read_b128 a[144:147], v32 offset:8448
    v_cvt_pk_bf16_f32 v223, v10, v11
    v_mfma_f32_16x16x32_bf16 v[232:235], a[124:127], a[28:31], v[232:235]
    v_exp_f32 v5, v5
    v_mfma_f32_16x16x32_bf16 v[240:243], a[124:127], a[60:63], v[20:23]
    ds_read_b128 a[140:143], v35 offset:8192
    v_cvt_pk_bf16_f32 v214, v4, v5
    v_mfma_f32_16x16x32_bf16 v[240:243], a[120:123], a[56:59], v[240:243]
    v_exp_f32 v6, v6
    v_mfma_f32_16x16x32_bf16 v[240:243], a[116:119], a[52:55], v[240:243]
    ds_read_b128 a[136:139], v34 offset:8192
    v_accvgpr_write_b32 a169, v69
    v_mfma_f32_16x16x32_bf16 v[240:243], a[112:115], a[48:51], v[240:243]
    v_exp_f32 v7, v7
    v_mfma_f32_16x16x32_bf16 v[240:243], a[108:111], a[44:47], v[240:243]
    ds_read_b128 a[132:135], v33 offset:8192
    v_cvt_pk_bf16_f32 v215, v6, v7
    v_mfma_f32_16x16x32_bf16 v[240:243], a[104:107], a[40:43], v[240:243]
    buffer_load_dwordx4 v58, s[20:23], s36 offen offset:2048 nt lds
    v_mfma_f32_16x16x32_bf16 v[240:243], a[100:103], a[36:39], v[240:243]
    ds_read_b128 a[128:131], v32 offset:8192
    v_accvgpr_write_b32 a170, v70
    v_mfma_f32_16x16x32_bf16 v[240:243], a[96:99], a[32:35], v[240:243]
    v_exp_f32 v232, v232
    v_mfma_f32_16x16x32_bf16 v[248:251], a[96:99], a[64:67], v[24:27]
L_pad3:
    s_cbranch_execz L_back
    v_exp_f32 v233, v233
    v_mfma_f32_16x16x32_bf16 v[248:251], a[100:103], a[68:71], v[248:251]
    v_exp_f32 v234, v234
    v_mfma_f32_16x16x32_bf16 v[248:251], a[104:107], a[72:75], v[248:251]
    v_exp_f32 v235, v235
    v_mfma_f32_16x16x32_bf16 v[248:251], a[108:111], a[76:79], v[248:251]
    v_accvgpr_write_b32 a171, v71
    v_mfma_f32_16x16x32_bf16 v[248:251], a[112:115], a[80:83], v[248:251]
    v_exp_f32 v240, v240
    v_mfma_f32_16x16x32_bf16 v[248:251], a[116:119], a[84:87], v[248:251]
    buffer_load_dwordx4 v59, s[20:23], s36 offen offset:3072 nt lds
    v_mfma_f32_16x16x32_bf16 v[248:251], a[120:123], a[88:91], v[248:251]
    v_exp_f32 v241, v241
    v_mfma_f32_16x16x32_bf16 v[248:251], a[124:127], a[92:95], v[248:251]
    s_waitcnt vmcnt(12) lgkmcnt(0)
    v_exp_f32 v242, v242
    v_mfma_f32_16x16x32_bf16 v[12:15], a[156:159], a[92:95], v[24:27]
    s_barrier
    ds_read_b128 a[96:99], v32 offset:16384
    v_cvt_pk_bf16_f32 v232, v232, v233
    v_mfma_f32_16x16x32_bf16 v[12:15], a[152:155], a[88:91], v[12:15]
    v_exp_f32 v243, v243
    v_mfma_f32_16x16x32_bf16 v[12:15], a[148:151], a[84:87], v[12:15]
    ds_read_b128 a[100:103], v33 offset:16384
    v_cvt_pk_bf16_f32 v233, v234, v235
    v_mfma_f32_16x16x32_bf16 v[12:15], a[144:147], a[80:83], v[12:15]
    s_add_u32 m0, s29, 147456
    v_accvgpr_write_b32 a176, v76
    v_mfma_f32_16x16x32_bf16 v[12:15], a[140:143], a[76:79], v[12:15]
    s_xor_b32 s36, s68, 196608
    ds_read_b128 a[104:107], v34 offset:16384
    v_cvt_pk_bf16_f32 v240, v240, v241
    v_mfma_f32_16x16x32_bf16 v[12:15], a[136:139], a[72:75], v[12:15]
    v_exp_f32 v248, v248
    v_mfma_f32_16x16x32_bf16 v[12:15], a[132:135], a[68:71], v[12:15]
    ds_read_b128 a[108:111], v35 offset:16384
    v_cvt_pk_bf16_f32 v241, v242, v243
    v_mfma_f32_16x16x32_bf16 v[12:15], a[128:131], a[64:67], v[12:15]
    buffer_load_dwordx4 v56, s[20:23], s36 offen offset:0 nt lds
    v_mfma_f32_16x16x32_bf16 v[8:11], a[128:131], a[32:35], v[20:23]
    ds_read_b128 a[112:115], v32 offset:16640
    v_accvgpr_write_b32 a177, v77
    v_mfma_f32_16x16x32_bf16 v[8:11], a[132:135], a[36:39], v[8:11]
    v_exp_f32 v249, v249
    v_mfma_f32_16x16x32_bf16 v[8:11], a[136:139], a[40:43], v[8:11]
    ds_read_b128 a[116:119], v33 offset:16640
    v_cvt_pk_bf16_f32 v248, v248, v249
    v_mfma_f32_16x16x32_bf16 v[8:11], a[140:143], a[44:47], v[8:11]
    v_exp_f32 v250, v250
    v_mfma_f32_16x16x32_bf16 v[8:11], a[144:147], a[48:51], v[8:11]
    ds_read_b128 a[120:123], v34 offset:16640
    v_accvgpr_write_b32 a178, v78
    v_mfma_f32_16x16x32_bf16 v[8:11], a[148:151], a[52:55], v[8:11]
    v_exp_f32 v251, v251
    v_mfma_f32_16x16x32_bf16 v[8:11], a[152:155], a[56:59], v[8:11]
    ds_read_b128 a[124:127], v35 offset:16640
    v_cvt_pk_bf16_f32 v249, v250, v251
    v_mfma_f32_16x16x32_bf16 v[8:11], a[156:159], a[60:63], v[8:11]
    v_exp_f32 v12, v12
    v_mfma_f32_16x16x32_bf16 v[4:7], a[156:159], a[28:31], v[16:19]
    buffer_load_dwordx4 v57, s[20:23], s36 offen offset:1024 nt lds
    v_mfma_f32_16x16x32_bf16 v[4:7], a[152:155], a[24:27], v[4:7]
    v_exp_f32 v13, v13
    v_mfma_f32_16x16x32_bf16 v[4:7], a[148:151], a[20:23], v[4:7]
    v_exp_f32 v14, v14
    v_mfma_f32_16x16x32_bf16 v[4:7], a[144:147], a[16:19], v[4:7]
    v_exp_f32 v15, v15
    v_mfma_f32_16x16x32_bf16 v[4:7], a[140:143], a[12:15], v[4:7]
    v_exp_f32 v8, v8
    v_mfma_f32_16x16x32_bf16 v[4:7], a[136:139], a[8:11], v[4:7]
    v_exp_f32 v9, v9
    v_mfma_f32_16x16x32_bf16 v[4:7], a[132:135], a[4:7], v[4:7]
    v_exp_f32 v10, v10
    v_mfma_f32_16x16x32_bf16 v[4:7], a[128:131], a[0:3], v[4:7]
    s_waitcnt lgkmcnt(0)
    v_exp_f32 v11, v11
    v_mfma_f32_16x16x32_bf16 v[236:239], a[96:99], a[0:3], v[16:19]
    ds_read_b128 a[156:159], v35 offset:24832
    v_cvt_pk_bf16_f32 v250, v12, v13
    v_mfma_f32_16x16x32_bf16 v[236:239], a[100:103], a[4:7], v[236:239]
    v_accvgpr_write_b32 a179, v79
    v_mfma_f32_16x16x32_bf16 v[236:239], a[104:107], a[8:11], v[236:239]
    ds_read_b128 a[152:155], v34 offset:24832
    v_cvt_pk_bf16_f32 v251, v14, v15
    v_mfma_f32_16x16x32_bf16 v[236:239], a[108:111], a[12:15], v[236:239]
    buffer_load_dwordx4 v58, s[20:23], s36 offen offset:2048 nt lds
    v_mfma_f32_16x16x32_bf16 v[236:239], a[112:115], a[16:19], v[236:239]
    ds_read_b128 a[148:151], v33 offset:24832
    v_cvt_pk_bf16_f32 v242, v8, v9
    v_mfma_f32_16x16x32_bf16 v[236:239], a[116:119], a[20:23], v[236:239]
    v_exp_f32 v4, v4
    v_mfma_f32_16x16x32_bf16 v[236:239], a[120:123], a[24:27], v[236:239]
    ds_read_b128 a[144:147], v32 offset:24832
    v_cvt_pk_bf16_f32 v243, v10, v11
    v_mfma_f32_16x16x32_bf16 v[236:239], a[124:127], a[28:31], v[236:239]
    v_exp_f32 v5, v5
    v_mfma_f32_16x16x32_bf16 v[244:247], a[124:127], a[60:63], v[20:23]
    ds_read_b128 a[140:143], v35 offset:24576
    v_cvt_pk_bf16_f32 v234, v4, v5
    v_mfma_f32_16x16x32_bf16 v[244:247], a[120:123], a[56:59], v[244:247]
    v_exp_f32 v6, v6
    v_mfma_f32_16x16x32_bf16 v[244:247], a[116:119], a[52:55], v[244:247]
    ds_read_b128 a[136:139], v34 offset:24576
    v_accvgpr_write_b32 a184, v84
    v_mfma_f32_16x16x32_bf16 v[244:247], a[112:115], a[48:51], v[244:247]
    buffer_load_dwordx4 v59, s[20:23], s36 offen offset:3072 nt lds
    v_mfma_f32_16x16x32_bf16 v[244:247], a[108:111], a[44:47], v[244:247]
    ds_read_b128 a[132:135], v33 offset:24576
    v_accvgpr_write_b32 a185, v85
    v_mfma_f32_16x16x32_bf16 v[244:247], a[104:107], a[40:43], v[244:247]
    v_exp_f32 v7, v7
    v_mfma_f32_16x16x32_bf16 v[244:247], a[100:103], a[36:39], v[244:247]
    ds_read_b128 a[128:131], v32 offset:24576
    v_cvt_pk_bf16_f32 v235, v6, v7
    v_mfma_f32_16x16x32_bf16 v[244:247], a[96:99], a[32:35], v[244:247]
    v_exp_f32 v236, v236
    v_mfma_f32_16x16x32_bf16 v[252:255], a[96:99], a[64:67], v[24:27]
    v_exp_f32 v237, v237
    v_mfma_f32_16x16x32_bf16 v[252:255], a[100:103], a[68:71], v[252:255]
    s_add_u32 m0, s29, 0
    v_exp_f32 v238, v238
    v_mfma_f32_16x16x32_bf16 v[252:255], a[104:107], a[72:75], v[252:255]
    s_xor_b32 s36, s68, 128
    v_exp_f32 v239, v239
    v_mfma_f32_16x16x32_bf16 v[252:255], a[108:111], a[76:79], v[252:255]
    v_accvgpr_write_b32 a186, v86
    v_mfma_f32_16x16x32_bf16 v[252:255], a[112:115], a[80:83], v[252:255]
    v_exp_f32 v244, v244
    v_mfma_f32_16x16x32_bf16 v[252:255], a[116:119], a[84:87], v[252:255]
    buffer_load_dwordx4 v56, s[20:23], s36 offen offset:0 nt lds
    v_mfma_f32_16x16x32_bf16 v[252:255], a[120:123], a[88:91], v[252:255]
    v_exp_f32 v245, v245
    v_mfma_f32_16x16x32_bf16 v[252:255], a[124:127], a[92:95], v[252:255]
    s_waitcnt vmcnt(9) lgkmcnt(0)
    v_exp_f32 v246, v246
    v_mfma_f32_16x16x32_bf16 v[12:15], a[156:159], a[92:95], v[24:27]
    s_barrier
    ds_read_b64_tr_b16 a[96:97], v44 offset:32768
    v_cvt_pk_bf16_f32 v236, v236, v237
    v_mfma_f32_16x16x32_bf16 v[12:15], a[152:155], a[88:91], v[12:15]
    ds_read_b64_tr_b16 a[98:99], v44 offset:34816
    v_cvt_pk_bf16_f32 v237, v238, v239
    v_mfma_f32_16x16x32_bf16 v[12:15], a[148:151], a[84:87], v[12:15]
    v_exp_f32 v247, v247
    v_mfma_f32_16x16x32_bf16 v[12:15], a[144:147], a[80:83], v[12:15]
    ds_read_b64_tr_b16 a[100:101], v44 offset:36864
    v_cvt_pk_bf16_f32 v244, v244, v245
    v_mfma_f32_16x16x32_bf16 v[12:15], a[140:143], a[76:79], v[12:15]
    ds_read_b64_tr_b16 a[102:103], v44 offset:38912
    v_cvt_pk_bf16_f32 v245, v246, v247
    v_mfma_f32_16x16x32_bf16 v[12:15], a[136:139], a[72:75], v[12:15]
    v_exp_f32 v252, v252
    v_mfma_f32_16x16x32_bf16 v[12:15], a[132:135], a[68:71], v[12:15]
    ds_read_b64_tr_b16 a[104:105], v44 offset:40960
    v_accvgpr_write_b32 a187, v87
    v_mfma_f32_16x16x32_bf16 v[12:15], a[128:131], a[64:67], v[12:15]
    ds_read_b64_tr_b16 a[106:107], v44 offset:43008
    v_mfma_f32_16x16x32_bf16 v[8:11], a[128:131], a[32:35], v[20:23]
    buffer_load_dwordx4 v57, s[20:23], s36 offen offset:1024 nt lds
    v_mfma_f32_16x16x32_bf16 v[8:11], a[132:135], a[36:39], v[8:11]
    ds_read_b64_tr_b16 a[108:109], v44 offset:45056
    v_mfma_f32_16x16x32_bf16 v[8:11], a[136:139], a[40:43], v[8:11]
    ds_read_b64_tr_b16 a[110:111], v44 offset:47104
    v_mfma_f32_16x16x32_bf16 v[8:11], a[140:143], a[44:47], v[8:11]
    v_exp_f32 v253, v253
    v_mfma_f32_16x16x32_bf16 v[8:11], a[144:147], a[48:51], v[8:11]
    ds_read_b64_tr_b16 a[112:113], v44 offset:49152
    v_cvt_pk_bf16_f32 v252, v252, v253
    v_mfma_f32_16x16x32_bf16 v[8:11], a[148:151], a[52:55], v[8:11]
    ds_read_b64_tr_b16 a[114:115], v44 offset:51200
    v_mfma_f32_16x16x32_bf16 v[8:11], a[152:155], a[56:59], v[8:11]
    v_exp_f32 v254, v254
    v_mfma_f32_16x16x32_bf16 v[8:11], a[156:159], a[60:63], v[8:11]
    ds_read_b64_tr_b16 a[116:117], v44 offset:53248
    v_mfma_f32_16x16x32_bf16 v[4:7], a[156:159], a[28:31], v[16:19]
    ds_read_b64_tr_b16 a[118:119], v44 offset:55296
    v_mfma_f32_16x16x32_bf16 v[4:7], a[152:155], a[24:27], v[4:7]
    buffer_load_dwordx4 v58, s[20:23], s36 offen offset:2048 nt lds
    v_mfma_f32_16x16x32_bf16 v[4:7], a[148:151], a[20:23], v[4:7]
    ds_read_b64_tr_b16 a[120:121], v44 offset:57344
    v_mfma_f32_16x16x32_bf16 v[4:7], a[144:147], a[16:19], v[4:7]
    ds_read_b64_tr_b16 a[122:123], v44 offset:59392
    v_mfma_f32_16x16x32_bf16 v[4:7], a[140:143], a[12:15], v[4:7]
    v_exp_f32 v255, v255
    v_mfma_f32_16x16x32_bf16 v[4:7], a[136:139], a[8:11], v[4:7]
    ds_read_b64_tr_b16 a[124:125], v44 offset:61440
    v_cvt_pk_bf16_f32 v253, v254, v255
    v_mfma_f32_16x16x32_bf16 v[4:7], a[132:135], a[4:7], v[4:7]
    ds_read_b64_tr_b16 a[126:127], v44 offset:63488
    v_mfma_f32_16x16x32_bf16 v[4:7], a[128:131], a[0:3], v[4:7]
    s_waitcnt lgkmcnt(5)
    v_exp_f32 v12, v12
    v_mfma_f32_16x16x32_bf16 v[64:67], a[96:99], a[164:167], 0
    ds_read_b64_tr_b16 a[156:157], v45 offset:61440
    v_mfma_f32_16x16x32_bf16 v[64:67], a[100:103], a[168:171], v[64:67]
    ds_read_b64_tr_b16 a[158:159], v45 offset:63488
    v_and_b32 v55, 1, v0
    v_mfma_f32_16x16x32_bf16 v[64:67], a[104:107], v[88:91], v[64:67]
    buffer_load_dwordx4 v59, s[20:23], s36 offen offset:3072 nt lds
    v_mfma_f32_16x16x32_bf16 v[64:67], a[108:111], v[92:95], v[64:67]
    ds_read_b64_tr_b16 a[152:153], v45 offset:57344
    v_sub_u32 v55, 0, v55
    v_mfma_f32_16x16x32_bf16 v[64:67], a[112:115], v[112:115], v[64:67]
    s_waitcnt lgkmcnt(5)
    ds_read_b64_tr_b16 a[154:155], v45 offset:59392
    v_and_b32 v55, 0xaaaaaaaa, v55
    v_mfma_f32_16x16x32_bf16 v[64:67], a[116:119], v[116:119], v[64:67]
    v_exp_f32 v13, v13
    v_mfma_f32_16x16x32_bf16 v[64:67], a[120:123], v[136:139], v[64:67]
    s_waitcnt lgkmcnt(4)
    ds_read_b64_tr_b16 a[148:149], v45 offset:53248
    v_cvt_pk_bf16_f32 v254, v12, v13
    v_mfma_f32_16x16x32_bf16 v[64:67], a[124:127], v[140:143], v[64:67]
    s_add_u32 m0, s29, 16384
    ds_read_b64_tr_b16 a[150:151], v45 offset:55296
    v_or_b32 v55, 0x44444444, v55
    v_mfma_f32_16x16x32_bf16 v[68:71], a[124:127], v[148:151], 0
    s_xor_b32 s36, s68, 65664
    v_exp_f32 v14, v14
    v_mfma_f32_16x16x32_bf16 v[68:71], a[120:123], v[144:147], v[68:71]
    ds_read_b64_tr_b16 a[144:145], v45 offset:49152
    v_mov_b32 v16, 0
    v_mfma_f32_16x16x32_bf16 v[68:71], a[116:119], v[124:127], v[68:71]
    ds_read_b64_tr_b16 a[146:147], v45 offset:51200
    v_mov_b32 v17, 0
    v_mfma_f32_16x16x32_bf16 v[68:71], a[112:115], v[120:123], v[68:71]
    buffer_load_dwordx4 v56, s[20:23], s36 offen offset:0 nt lds
    v_mfma_f32_16x16x32_bf16 v[68:71], a[108:111], v[100:103], v[68:71]
    ds_read_b64_tr_b16 a[140:141], v45 offset:45056
    v_mov_b32 v20, 0
    v_mfma_f32_16x16x32_bf16 v[68:71], a[104:107], v[96:99], v[68:71]
    ds_read_b64_tr_b16 a[142:143], v45 offset:47104
    v_mov_b32 v21, 0
    v_mfma_f32_16x16x32_bf16 v[68:71], a[100:103], a[176:179], v[68:71]
    v_exp_f32 v15, v15
    v_mfma_f32_16x16x32_bf16 v[68:71], a[96:99], a[172:175], v[68:71]
    ds_read_b64_tr_b16 a[136:137], v45 offset:40960
    v_cvt_pk_bf16_f32 v255, v14, v15
    v_mfma_f32_16x16x32_bf16 v[72:75], a[96:99], a[180:183], 0
    ds_read_b64_tr_b16 a[138:139], v45 offset:43008
    v_mov_b32 v24, 0
    v_mfma_f32_16x16x32_bf16 v[72:75], a[100:103], a[184:187], v[72:75]
    v_exp_f32 v8, v8
    v_mfma_f32_16x16x32_bf16 v[72:75], a[104:107], v[104:107], v[72:75]
    ds_read_b64_tr_b16 a[132:133], v45 offset:36864
    v_mov_b32 v25, 0
    v_mfma_f32_16x16x32_bf16 v[72:75], a[108:111], v[108:111], v[72:75]
    ds_read_b64_tr_b16 a[134:135], v45 offset:38912
    v_mfma_f32_16x16x32_bf16 v[72:75], a[112:115], v[128:131], v[72:75]
    buffer_load_dwordx4 v57, s[20:23], s36 offen offset:1024 nt lds
    v_mfma_f32_16x16x32_bf16 v[72:75], a[116:119], v[132:135], v[72:75]
    ds_read_b64_tr_b16 a[128:129], v45 offset:32768
    v_mfma_f32_16x16x32_bf16 v[72:75], a[120:123], v[152:155], v[72:75]
    ds_read_b64_tr_b16 a[130:131], v45 offset:34816
    v_mfma_f32_16x16x32_bf16 v[72:75], a[124:127], v[156:159], v[72:75]
    s_waitcnt lgkmcnt(5)
    v_exp_f32 v9, v9
    v_mfma_f32_16x16x32_bf16 v[84:87], a[156:159], v[156:159], 0
    ds_read_b64_tr_b16 a[96:97], v46 offset:32768
    v_cvt_pk_bf16_f32 v246, v8, v9
    v_mfma_f32_16x16x32_bf16 v[84:87], a[152:155], v[152:155], v[84:87]
    v_exp_f32 v10, v10
    v_mfma_f32_16x16x32_bf16 v[84:87], a[148:151], v[132:135], v[84:87]
    ds_read_b64_tr_b16 a[98:99], v46 offset:34816
    v_mfma_f32_16x16x32_bf16 v[84:87], a[144:147], v[128:131], v[84:87]
    v_exp_f32 v11, v11
    v_mfma_f32_16x16x32_bf16 v[84:87], a[140:143], v[108:111], v[84:87]
    s_waitcnt lgkmcnt(4)
    ds_read_b64_tr_b16 a[100:101], v46 offset:36864
    v_cvt_pk_bf16_f32 v247, v10, v11
    v_mfma_f32_16x16x32_bf16 v[84:87], a[136:139], v[104:107], v[84:87]
    v_exp_f32 v4, v4
    v_mfma_f32_16x16x32_bf16 v[84:87], a[132:135], a[184:187], v[84:87]
    s_waitcnt lgkmcnt(3)
    ds_read_b64_tr_b16 a[102:103], v46 offset:38912
    v_mfma_f32_16x16x32_bf16 v[84:87], a[128:131], a[180:183], v[84:87]
    buffer_load_dwordx4 v58, s[20:23], s36 offen offset:2048 nt lds
    v_mfma_f32_16x16x32_bf16 v[80:83], a[128:131], a[172:175], 0
    ds_read_b64_tr_b16 a[104:105], v46 offset:40960
    v_mfma_f32_16x16x32_bf16 v[80:83], a[132:135], a[176:179], v[80:83]
    v_exp_f32 v5, v5
    v_mfma_f32_16x16x32_bf16 v[80:83], a[136:139], v[96:99], v[80:83]
    ds_read_b64_tr_b16 a[106:107], v46 offset:43008
    v_cvt_pk_bf16_f32 v238, v4, v5
    v_mfma_f32_16x16x32_bf16 v[80:83], a[140:143], v[100:103], v[80:83]
    v_exp_f32 v6, v6
    v_mfma_f32_16x16x32_bf16 v[80:83], a[144:147], v[120:123], v[80:83]
    ds_read_b64_tr_b16 a[108:109], v46 offset:45056
    v_mfma_f32_16x16x32_bf16 v[80:83], a[148:151], v[124:127], v[80:83]
    v_exp_f32 v7, v7
    v_mfma_f32_16x16x32_bf16 v[80:83], a[152:155], v[144:147], v[80:83]
    ds_read_b64_tr_b16 a[110:111], v46 offset:47104
    v_cvt_pk_bf16_f32 v239, v6, v7
    v_mfma_f32_16x16x32_bf16 v[80:83], a[156:159], v[148:151], v[80:83]
    buffer_load_dwordx4 v59, s[20:23], s36 offen offset:3072 nt lds
    v_mfma_f32_16x16x32_bf16 v[76:79], a[156:159], v[140:143], 0
    ds_read_b64_tr_b16 a[112:113], v46 offset:49152
    v_mfma_f32_16x16x32_bf16 v[76:79], a[152:155], v[136:139], v[76:79]
    v_mfma_f32_16x16x32_bf16 v[76:79], a[148:151], v[116:119], v[76:79]
    ds_read_b64_tr_b16 a[114:115], v46 offset:51200
    v_mfma_f32_16x16x32_bf16 v[76:79], a[144:147], v[112:115], v[76:79]
    v_mfma_f32_16x16x32_bf16 v[76:79], a[140:143], v[92:95], v[76:79]
    ds_read_b64_tr_b16 a[116:117], v46 offset:53248
    v_mfma_f32_16x16x32_bf16 v[76:79], a[136:139], v[88:91], v[76:79]
    s_add_u32 m0, s29, 32768
    v_mfma_f32_16x16x32_bf16 v[76:79], a[132:135], a[168:171], v[76:79]
    s_xor_b32 s36, s68, 131200
    ds_read_b64_tr_b16 a[118:119], v46 offset:55296
    v_mfma_f32_16x16x32_bf16 v[76:79], a[128:131], a[164:167], v[76:79]
    v_smfmac_f32_16x16x64_bf16 v[24:27], a[160:163], a[180:187], v55
    ds_read_b64_tr_b16 a[120:121], v46 offset:57344
    v_smfmac_f32_16x16x64_bf16 v[24:27], a[160:163], v[104:111], v55
    ds_read_b64_tr_b16 a[122:123], v46 offset:59392
    v_smfmac_f32_16x16x64_bf16 v[24:27], a[160:163], v[128:135], v55
    ds_read_b64_tr_b16 a[124:125], v46 offset:61440
    v_smfmac_f32_16x16x64_bf16 v[24:27], a[160:163], v[152:159], v55
    ds_read_b64_tr_b16 a[126:127], v46 offset:63488
    v_smfmac_f32_16x16x64_bf16 v[24:27], a[160:163], v[176:183], v55
    v_smfmac_f32_16x16x64_bf16 v[24:27], a[160:163], v[200:207], v55
    v_smfmac_f32_16x16x64_bf16 v[24:27], a[160:163], v[224:231], v55
    v_smfmac_f32_16x16x64_bf16 v[24:27], a[160:163], v[248:255], v55
    s_waitcnt lgkmcnt(4)
    v_mfma_f32_16x16x32_bf16 v[28:31], a[96:99], a[164:167], 0
    ds_read_b64_tr_b16 a[156:157], v47 offset:61440
    v_mfma_f32_16x16x32_bf16 v[28:31], a[100:103], a[168:171], v[28:31]
    buffer_load_dwordx4 v56, s[20:23], s36 offen offset:0 nt lds
    v_mfma_f32_16x16x32_bf16 v[28:31], a[104:107], v[88:91], v[28:31]
    ds_read_b64_tr_b16 a[158:159], v47 offset:63488
    v_mfma_f32_16x16x32_bf16 v[28:31], a[108:111], v[92:95], v[28:31]
    buffer_load_dwordx4 v57, s[20:23], s36 offen offset:1024 nt lds
    v_mfma_f32_16x16x32_bf16 v[28:31], a[112:115], v[112:115], v[28:31]
    ds_read_b64_tr_b16 a[152:153], v47 offset:57344
    v_mfma_f32_16x16x32_bf16 v[28:31], a[116:119], v[116:119], v[28:31]
    s_waitcnt lgkmcnt(3)
    v_mfma_f32_16x16x32_bf16 v[28:31], a[120:123], v[136:139], v[28:31]
    ds_read_b64_tr_b16 a[154:155], v47 offset:59392
    v_mfma_f32_16x16x32_bf16 v[28:31], a[124:127], v[140:143], v[28:31]
    v_mfma_f32_16x16x32_bf16 v[32:35], a[124:127], v[148:151], 0
    ds_read_b64_tr_b16 a[148:149], v47 offset:53248
    v_mfma_f32_16x16x32_bf16 v[32:35], a[120:123], v[144:147], v[32:35]
    v_mfma_f32_16x16x32_bf16 v[32:35], a[116:119], v[124:127], v[32:35]
    ds_read_b64_tr_b16 a[150:151], v47 offset:55296
    v_mfma_f32_16x16x32_bf16 v[32:35], a[112:115], v[120:123], v[32:35]
    v_add_f32 v24, v24, v25
    v_mfma_f32_16x16x32_bf16 v[32:35], a[108:111], v[100:103], v[32:35]
    ds_read_b64_tr_b16 a[144:145], v47 offset:49152
    v_mfma_f32_16x16x32_bf16 v[32:35], a[104:107], v[96:99], v[32:35]
    buffer_load_dwordx4 v58, s[20:23], s36 offen offset:2048 nt lds
    v_mfma_f32_16x16x32_bf16 v[32:35], a[100:103], a[176:179], v[32:35]
    ds_read_b64_tr_b16 a[146:147], v47 offset:51200
    v_mfma_f32_16x16x32_bf16 v[32:35], a[96:99], a[172:175], v[32:35]
    v_rcp_f32 v3, v24
    v_mfma_f32_16x16x32_bf16 v[36:39], a[96:99], a[180:183], 0
    ds_read_b64_tr_b16 a[140:141], v47 offset:45056
    v_mfma_f32_16x16x32_bf16 v[36:39], a[100:103], a[184:187], v[36:39]
    v_mfma_f32_16x16x32_bf16 v[36:39], a[104:107], v[104:107], v[36:39]
    ds_read_b64_tr_b16 a[142:143], v47 offset:47104
    v_mfma_f32_16x16x32_bf16 v[36:39], a[108:111], v[108:111], v[36:39]
    v_mfma_f32_16x16x32_bf16 v[36:39], a[112:115], v[128:131], v[36:39]
    ds_read_b64_tr_b16 a[136:137], v47 offset:40960
    v_mfma_f32_16x16x32_bf16 v[36:39], a[116:119], v[132:135], v[36:39]
    buffer_load_dwordx4 v59, s[20:23], s36 offen offset:3072 nt lds
    v_mfma_f32_16x16x32_bf16 v[36:39], a[120:123], v[152:155], v[36:39]
    ds_read_b64_tr_b16 a[138:139], v47 offset:43008
    v_mfma_f32_16x16x32_bf16 v[36:39], a[124:127], v[156:159], v[36:39]
    v_smfmac_f32_16x16x64_bf16 v[20:23], a[160:163], a[172:179], v55
    ds_read_b64_tr_b16 a[132:133], v47 offset:36864
    v_smfmac_f32_16x16x64_bf16 v[20:23], a[160:163], v[96:103], v55
    ds_read_b64_tr_b16 a[134:135], v47 offset:38912
    v_smfmac_f32_16x16x64_bf16 v[20:23], a[160:163], v[120:127], v55
    ds_read_b64_tr_b16 a[128:129], v47 offset:32768
    v_smfmac_f32_16x16x64_bf16 v[20:23], a[160:163], v[144:151], v55
    s_add_u32 m0, s29, 49152
    ds_read_b64_tr_b16 a[130:131], v47 offset:34816
    v_smfmac_f32_16x16x64_bf16 v[20:23], a[160:163], v[168:175], v55
    s_xor_b32 s36, s68, 196736
    v_smfmac_f32_16x16x64_bf16 v[20:23], a[160:163], v[192:199], v55
    v_smfmac_f32_16x16x64_bf16 v[20:23], a[160:163], v[216:223], v55
    v_smfmac_f32_16x16x64_bf16 v[20:23], a[160:163], v[240:247], v55
    s_waitcnt vmcnt(12) lgkmcnt(4)
    v_mfma_f32_16x16x32_bf16 v[12:15], a[156:159], v[156:159], 0
    s_barrier
    ds_read_b64_tr_b16 a[96:97], v48 offset:0
    v_mfma_f32_16x16x32_bf16 v[12:15], a[152:155], v[152:155], v[12:15]
    buffer_load_dwordx4 v56, s[20:23], s36 offen offset:0 nt lds
    v_mfma_f32_16x16x32_bf16 v[12:15], a[148:151], v[132:135], v[12:15]
    ds_read_b64_tr_b16 a[98:99], v48 offset:2048
    v_mfma_f32_16x16x32_bf16 v[12:15], a[144:147], v[128:131], v[12:15]
    v_mfma_f32_16x16x32_bf16 v[12:15], a[140:143], v[108:111], v[12:15]
    ds_read_b64_tr_b16 a[100:101], v48 offset:4096
    v_mfma_f32_16x16x32_bf16 v[12:15], a[136:139], v[104:107], v[12:15]
    s_waitcnt lgkmcnt(3)
    v_mfma_f32_16x16x32_bf16 v[12:15], a[132:135], a[184:187], v[12:15]
    ds_read_b64_tr_b16 a[102:103], v48 offset:6144
    v_mfma_f32_16x16x32_bf16 v[12:15], a[128:131], a[180:183], v[12:15]
    v_mfma_f32_16x16x32_bf16 v[8:11], a[128:131], a[172:175], 0
    ds_read_b64_tr_b16 a[104:105], v48 offset:8192
    v_mfma_f32_16x16x32_bf16 v[8:11], a[132:135], a[176:179], v[8:11]
    buffer_load_dwordx4 v57, s[20:23], s36 offen offset:1024 nt lds
    v_mfma_f32_16x16x32_bf16 v[8:11], a[136:139], v[96:99], v[8:11]
    ds_read_b64_tr_b16 a[106:107], v48 offset:10240
    v_mfma_f32_16x16x32_bf16 v[8:11], a[140:143], v[100:103], v[8:11]
    v_add_f32 v20, v20, v21
    v_mfma_f32_16x16x32_bf16 v[8:11], a[144:147], v[120:123], v[8:11]
    ds_read_b64_tr_b16 a[108:109], v48 offset:12288
    v_mfma_f32_16x16x32_bf16 v[8:11], a[148:151], v[124:127], v[8:11]
    v_rcp_f32 v2, v20
    v_mfma_f32_16x16x32_bf16 v[8:11], a[152:155], v[144:147], v[8:11]
    ds_read_b64_tr_b16 a[110:111], v48 offset:14336
    v_mfma_f32_16x16x32_bf16 v[8:11], a[156:159], v[148:151], v[8:11]
    v_mfma_f32_16x16x32_bf16 v[4:7], a[156:159], v[140:143], 0
    ds_read_b64_tr_b16 a[112:113], v48 offset:16384
    v_mfma_f32_16x16x32_bf16 v[4:7], a[152:155], v[136:139], v[4:7]
    v_mfma_f32_16x16x32_bf16 v[4:7], a[148:151], v[116:119], v[4:7]
    ds_read_b64_tr_b16 a[114:115], v48 offset:18432
    v_mfma_f32_16x16x32_bf16 v[4:7], a[144:147], v[112:115], v[4:7]
    buffer_load_dwordx4 v58, s[20:23], s36 offen offset:2048 nt lds
    v_mfma_f32_16x16x32_bf16 v[4:7], a[140:143], v[92:95], v[4:7]
    ds_read_b64_tr_b16 a[116:117], v48 offset:20480
    v_mfma_f32_16x16x32_bf16 v[4:7], a[136:139], v[88:91], v[4:7]
    v_mfma_f32_16x16x32_bf16 v[4:7], a[132:135], a[168:171], v[4:7]
    ds_read_b64_tr_b16 a[118:119], v48 offset:22528
    v_mfma_f32_16x16x32_bf16 v[4:7], a[128:131], a[164:167], v[4:7]
    v_smfmac_f32_16x16x64_bf16 v[16:19], a[160:163], a[164:171], v55
    ds_read_b64_tr_b16 a[120:121], v48 offset:24576
    v_smfmac_f32_16x16x64_bf16 v[16:19], a[160:163], v[88:95], v55
    ds_read_b64_tr_b16 a[122:123], v48 offset:26624
    v_smfmac_f32_16x16x64_bf16 v[16:19], a[160:163], v[112:119], v55
    ds_read_b64_tr_b16 a[124:125], v48 offset:28672
    v_smfmac_f32_16x16x64_bf16 v[16:19], a[160:163], v[136:143], v55
    ds_read_b64_tr_b16 a[126:127], v48 offset:30720
    v_smfmac_f32_16x16x64_bf16 v[16:19], a[160:163], v[160:167], v55
    v_smfmac_f32_16x16x64_bf16 v[16:19], a[160:163], v[184:191], v55
    v_smfmac_f32_16x16x64_bf16 v[16:19], a[160:163], v[208:215], v55
    v_smfmac_f32_16x16x64_bf16 v[16:19], a[160:163], v[232:239], v55
    s_waitcnt lgkmcnt(4)
    v_mfma_f32_16x16x32_bf16 v[64:67], a[96:99], v[160:163], v[64:67]
    ds_read_b64_tr_b16 a[156:157], v49 offset:28672
    v_mfma_f32_16x16x32_bf16 v[64:67], a[100:103], v[164:167], v[64:67]
    ds_read_b64_tr_b16 a[158:159], v49 offset:30720
    v_mfma_f32_16x16x32_bf16 v[64:67], a[104:107], v[184:187], v[64:67]
    buffer_load_dwordx4 v59, s[20:23], s36 offen offset:3072 nt lds
    v_mfma_f32_16x16x32_bf16 v[64:67], a[108:111], v[188:191], v[64:67]
    s_add_u32 m0, s29, 65536
    ds_read_b64_tr_b16 a[152:153], v49 offset:24576
    v_mfma_f32_16x16x32_bf16 v[64:67], a[112:115], v[208:211], v[64:67]
    s_xor_b32 s36, s68, 256
    ds_read_b64_tr_b16 a[154:155], v49 offset:26624
    v_mfma_f32_16x16x32_bf16 v[64:67], a[116:119], v[212:215], v[64:67]
    s_waitcnt lgkmcnt(4)
    buffer_load_dwordx4 v56, s[20:23], s36 offen offset:0 nt lds
    v_mfma_f32_16x16x32_bf16 v[64:67], a[120:123], v[232:235], v[64:67]
    ds_read_b64_tr_b16 a[148:149], v49 offset:20480
    v_mfma_f32_16x16x32_bf16 v[64:67], a[124:127], v[236:239], v[64:67]
    ds_read_b64_tr_b16 a[150:151], v49 offset:22528
    v_mfma_f32_16x16x32_bf16 v[68:71], a[124:127], v[244:247], v[68:71]
    v_mfma_f32_16x16x32_bf16 v[68:71], a[120:123], v[240:243], v[68:71]
    ds_read_b64_tr_b16 a[144:145], v49 offset:16384
    v_mfma_f32_16x16x32_bf16 v[68:71], a[116:119], v[220:223], v[68:71]
    ds_read_b64_tr_b16 a[146:147], v49 offset:18432
    v_mfma_f32_16x16x32_bf16 v[68:71], a[112:115], v[216:219], v[68:71]
    v_add_f32 v16, v16, v17
    v_mfma_f32_16x16x32_bf16 v[68:71], a[108:111], v[196:199], v[68:71]
    ds_read_b64_tr_b16 a[140:141], v49 offset:12288
    v_mfma_f32_16x16x32_bf16 v[68:71], a[104:107], v[192:195], v[68:71]
    ds_read_b64_tr_b16 a[142:143], v49 offset:14336
    v_mfma_f32_16x16x32_bf16 v[68:71], a[100:103], v[172:175], v[68:71]
    buffer_load_dwordx4 v57, s[20:23], s36 offen offset:1024 nt lds
    v_mfma_f32_16x16x32_bf16 v[68:71], a[96:99], v[168:171], v[68:71]
    ds_read_b64_tr_b16 a[136:137], v49 offset:8192
    v_mfma_f32_16x16x32_bf16 v[72:75], a[96:99], v[176:179], v[72:75]
    ds_read_b64_tr_b16 a[138:139], v49 offset:10240
    v_mfma_f32_16x16x32_bf16 v[72:75], a[100:103], v[180:183], v[72:75]
    v_rcp_f32 v1, v16
    v_mfma_f32_16x16x32_bf16 v[72:75], a[104:107], v[200:203], v[72:75]
    ds_read_b64_tr_b16 a[132:133], v49 offset:4096
    v_add_f32 v52, v16, v20
    v_mfma_f32_16x16x32_bf16 v[72:75], a[108:111], v[204:207], v[72:75]
    ds_read_b64_tr_b16 a[134:135], v49 offset:6144
    v_add_f32 v52, v52, v24
    v_mfma_f32_16x16x32_bf16 v[72:75], a[112:115], v[224:227], v[72:75]
    v_cmp_ngt_f32 vcc, 0x5f800000, v52
    v_mul_f32 v64, v64, v1
    v_mfma_f32_16x16x32_bf16 v[72:75], a[116:119], v[228:231], v[72:75]
    ds_read_b64_tr_b16 a[128:129], v49 offset:0
    v_mul_f32 v65, v65, v1
    v_mfma_f32_16x16x32_bf16 v[72:75], a[120:123], v[248:251], v[72:75]
    s_cmp_lg_u64 vcc, 0
    s_cselect_b32 s64, 1, 0
    ds_read_b64_tr_b16 a[130:131], v49 offset:2048
    v_mfma_f32_16x16x32_bf16 v[72:75], a[124:127], v[252:255], v[72:75]
    s_waitcnt lgkmcnt(5)
    v_mul_f32 v66, v66, v1
    v_mul_f32 v67, v67, v1
    v_mfma_f32_16x16x32_bf16 v[84:87], a[156:159], v[252:255], v[84:87]
    ds_read_b64_tr_b16 a[96:97], v50 offset:0
    v_mul_f32 v68, v68, v2
    v_mfma_f32_16x16x32_bf16 v[84:87], a[152:155], v[248:251], v[84:87]
    ds_read_b64_tr_b16 a[98:99], v50 offset:2048
    v_mul_f32 v69, v69, v2
    v_mfma_f32_16x16x32_bf16 v[84:87], a[148:151], v[228:231], v[84:87]
    buffer_load_dwordx4 v58, s[20:23], s36 offen offset:2048 nt lds
    v_mfma_f32_16x16x32_bf16 v[84:87], a[144:147], v[224:227], v[84:87]
    ds_read_b64_tr_b16 a[100:101], v50 offset:4096
    v_mul_f32 v70, v70, v2
    v_mfma_f32_16x16x32_bf16 v[84:87], a[140:143], v[204:207], v[84:87]
    s_waitcnt lgkmcnt(5)
    ds_read_b64_tr_b16 a[102:103], v50 offset:6144
    v_mul_f32 v71, v71, v2
    v_mfma_f32_16x16x32_bf16 v[84:87], a[136:139], v[200:203], v[84:87]
    v_mul_f32 v72, v72, v3
    v_mul_f32 v73, v73, v3
    v_mfma_f32_16x16x32_bf16 v[84:87], a[132:135], v[180:183], v[84:87]
    s_waitcnt lgkmcnt(4)
    ds_read_b64_tr_b16 a[104:105], v50 offset:8192
    v_mul_f32 v74, v74, v3
    v_mfma_f32_16x16x32_bf16 v[84:87], a[128:131], v[176:179], v[84:87]
    ds_read_b64_tr_b16 a[106:107], v50 offset:10240
    v_mul_f32 v75, v75, v3
    v_mfma_f32_16x16x32_bf16 v[80:83], a[128:131], v[168:171], v[80:83]
    v_mfma_f32_16x16x32_bf16 v[80:83], a[132:135], v[172:175], v[80:83]
    ds_read_b64_tr_b16 a[108:109], v50 offset:12288
    v_mfma_f32_16x16x32_bf16 v[80:83], a[136:139], v[192:195], v[80:83]
    ds_read_b64_tr_b16 a[110:111], v50 offset:14336
    v_mfma_f32_16x16x32_bf16 v[80:83], a[140:143], v[196:199], v[80:83]
    buffer_load_dwordx4 v59, s[20:23], s36 offen offset:3072 nt lds
    v_mfma_f32_16x16x32_bf16 v[80:83], a[144:147], v[216:219], v[80:83]
    ds_read_b64_tr_b16 a[112:113], v50 offset:16384
    v_mul_f32 v84, v84, v3
    v_mfma_f32_16x16x32_bf16 v[80:83], a[148:151], v[220:223], v[80:83]
    ds_read_b64_tr_b16 a[114:115], v50 offset:18432
    v_mul_f32 v85, v85, v3
    v_mfma_f32_16x16x32_bf16 v[80:83], a[152:155], v[240:243], v[80:83]
    v_mul_f32 v86, v86, v3
    v_mul_f32 v87, v87, v3
    v_mfma_f32_16x16x32_bf16 v[80:83], a[156:159], v[244:247], v[80:83]
    s_add_u32 m0, s29, 81920
    ds_read_b64_tr_b16 a[116:117], v50 offset:20480
    v_cvt_pk_bf16_f32 v87, v86, v87
    v_mfma_f32_16x16x32_bf16 v[76:79], a[156:159], v[236:239], v[76:79]
    s_xor_b32 s36, s68, 65792
    ds_read_b64_tr_b16 a[118:119], v50 offset:22528
    v_cvt_pk_bf16_f32 v86, v84, v85
    v_mfma_f32_16x16x32_bf16 v[76:79], a[152:155], v[232:235], v[76:79]
    v_cvt_pk_bf16_f32 v84, v72, v73
    v_mfma_f32_16x16x32_bf16 v[76:79], a[148:151], v[212:215], v[76:79]
    ds_read_b64_tr_b16 a[120:121], v50 offset:24576
    v_cvt_pk_bf16_f32 v85, v74, v75
    v_mfma_f32_16x16x32_bf16 v[76:79], a[144:147], v[208:211], v[76:79]
    ds_read_b64_tr_b16 a[122:123], v50 offset:26624
    v_mul_f32 v80, v80, v2
    v_mfma_f32_16x16x32_bf16 v[76:79], a[140:143], v[188:191], v[76:79]
    buffer_load_dwordx4 v56, s[20:23], s36 offen offset:0 nt lds
    v_mfma_f32_16x16x32_bf16 v[76:79], a[136:139], v[184:187], v[76:79]
    ds_read_b64_tr_b16 a[124:125], v50 offset:28672
    v_mul_f32 v81, v81, v2
    v_mfma_f32_16x16x32_bf16 v[76:79], a[132:135], v[164:167], v[76:79]
    ds_read_b64_tr_b16 a[126:127], v50 offset:30720
    v_mul_f32 v82, v82, v2
    v_mfma_f32_16x16x32_bf16 v[76:79], a[128:131], v[160:163], v[76:79]
    s_waitcnt lgkmcnt(5)
    v_permlane16_swap_b32 v84, v86
    v_mfma_f32_16x16x32_bf16 v[28:31], a[96:99], v[160:163], v[28:31]
    ds_read_b64_tr_b16 a[156:157], v51 offset:28672
    v_mul_f32 v83, v83, v2
    v_mfma_f32_16x16x32_bf16 v[28:31], a[100:103], v[164:167], v[28:31]
L_pad4:
    s_cbranch_execz L_back
    ds_read_b64_tr_b16 a[158:159], v51 offset:30720
    v_cvt_pk_bf16_f32 v83, v82, v83
    v_mfma_f32_16x16x32_bf16 v[28:31], a[104:107], v[184:187], v[28:31]
    v_permlane16_swap_b32 v85, v87
    v_mfma_f32_16x16x32_bf16 v[28:31], a[108:111], v[188:191], v[28:31]
    ds_read_b64_tr_b16 a[152:153], v51 offset:24576
    v_cvt_pk_bf16_f32 v82, v80, v81
    v_mfma_f32_16x16x32_bf16 v[28:31], a[112:115], v[208:211], v[28:31]
    s_waitcnt lgkmcnt(5)
    ds_read_b64_tr_b16 a[154:155], v51 offset:26624
    v_cvt_pk_bf16_f32 v80, v68, v69
    v_mfma_f32_16x16x32_bf16 v[28:31], a[116:119], v[212:215], v[28:31]
    buffer_load_dwordx4 v57, s[20:23], s36 offen offset:1024 nt lds
    v_mfma_f32_16x16x32_bf16 v[28:31], a[120:123], v[232:235], v[28:31]
    s_waitcnt lgkmcnt(4)
    ds_read_b64_tr_b16 a[148:149], v51 offset:20480
    v_cvt_pk_bf16_f32 v81, v70, v71
    v_mfma_f32_16x16x32_bf16 v[28:31], a[124:127], v[236:239], v[28:31]
    ds_read_b64_tr_b16 a[150:151], v51 offset:22528
    v_mul_f32 v76, v76, v1
    v_mfma_f32_16x16x32_bf16 v[32:35], a[124:127], v[244:247], v[32:35]
    v_permlane16_swap_b32 v80, v82
    v_mfma_f32_16x16x32_bf16 v[32:35], a[120:123], v[240:243], v[32:35]
    ds_read_b64_tr_b16 a[144:145], v51 offset:16384
    v_mul_f32 v77, v77, v1
    v_mfma_f32_16x16x32_bf16 v[32:35], a[116:119], v[220:223], v[32:35]
    ds_read_b64_tr_b16 a[146:147], v51 offset:18432
    v_mul_f32 v78, v78, v1
    v_mfma_f32_16x16x32_bf16 v[32:35], a[112:115], v[216:219], v[32:35]
    v_permlane16_swap_b32 v81, v83
    v_mfma_f32_16x16x32_bf16 v[32:35], a[108:111], v[196:199], v[32:35]
    ds_read_b64_tr_b16 a[140:141], v51 offset:12288
    v_mul_f32 v79, v79, v1
    v_mfma_f32_16x16x32_bf16 v[32:35], a[104:107], v[192:195], v[32:35]
    ds_read_b64_tr_b16 a[142:143], v51 offset:14336
    v_cvt_pk_bf16_f32 v79, v78, v79
    v_mfma_f32_16x16x32_bf16 v[32:35], a[100:103], v[172:175], v[32:35]
    buffer_load_dwordx4 v58, s[20:23], s36 offen offset:2048 nt lds
    v_mfma_f32_16x16x32_bf16 v[32:35], a[96:99], v[168:171], v[32:35]
    ds_read_b64_tr_b16 a[136:137], v51 offset:8192
    v_cvt_pk_bf16_f32 v78, v76, v77
    v_mfma_f32_16x16x32_bf16 v[36:39], a[96:99], v[176:179], v[36:39]
    ds_read_b64_tr_b16 a[138:139], v51 offset:10240
    v_cvt_pk_bf16_f32 v76, v64, v65
    v_mfma_f32_16x16x32_bf16 v[36:39], a[100:103], v[180:183], v[36:39]
    v_cvt_pk_bf16_f32 v77, v66, v67
    v_mul_f32 v28, v28, v1
    v_mfma_f32_16x16x32_bf16 v[36:39], a[104:107], v[200:203], v[36:39]
    ds_read_b64_tr_b16 a[132:133], v51 offset:4096
    v_mul_f32 v29, v29, v1
    v_mfma_f32_16x16x32_bf16 v[36:39], a[108:111], v[204:207], v[36:39]
    ds_read_b64_tr_b16 a[134:135], v51 offset:6144
    v_mul_f32 v30, v30, v1
    v_mfma_f32_16x16x32_bf16 v[36:39], a[112:115], v[224:227], v[36:39]
    v_permlane16_swap_b32 v76, v78
    v_mfma_f32_16x16x32_bf16 v[36:39], a[116:119], v[228:231], v[36:39]
    ds_read_b64_tr_b16 a[128:129], v51 offset:0
    v_mul_f32 v31, v31, v1
    v_mfma_f32_16x16x32_bf16 v[36:39], a[120:123], v[248:251], v[36:39]
    ds_read_b64_tr_b16 a[130:131], v51 offset:2048
    v_cvt_pk_bf16_f32 v28, v28, v29
    v_mfma_f32_16x16x32_bf16 v[36:39], a[124:127], v[252:255], v[36:39]
    s_waitcnt vmcnt(15) lgkmcnt(5)
    buffer_load_dwordx4 v59, s[20:23], s36 offen offset:3072 nt lds
    v_mfma_f32_16x16x32_bf16 v[12:15], a[156:159], v[252:255], v[12:15]
    s_barrier
    ds_read_b64_tr_b16 a[96:97], v40 offset:0
    v_cvt_pk_bf16_f32 v29, v30, v31
    v_mfma_f32_16x16x32_bf16 v[12:15], a[152:155], v[248:251], v[12:15]
    ds_read_b64_tr_b16 a[98:99], v40 offset:2048
    v_mul_f32 v32, v32, v2
    v_mfma_f32_16x16x32_bf16 v[12:15], a[148:151], v[228:231], v[12:15]
    v_permlane16_swap_b32 v77, v79
    v_mfma_f32_16x16x32_bf16 v[12:15], a[144:147], v[224:227], v[12:15]
    ds_read_b64_tr_b16 a[100:101], v40 offset:4096
    v_mul_f32 v33, v33, v2
    v_mfma_f32_16x16x32_bf16 v[12:15], a[140:143], v[204:207], v[12:15]
    s_waitcnt lgkmcnt(3)
    ds_read_b64_tr_b16 a[102:103], v40 offset:6144
    v_mul_f32 v34, v34, v2
    v_mfma_f32_16x16x32_bf16 v[12:15], a[136:139], v[200:203], v[12:15]
    s_add_u32 m0, s29, 98304
    v_mul_f32 v35, v35, v2
    v_cvt_pk_bf16_f32 v32, v32, v33
    v_mfma_f32_16x16x32_bf16 v[12:15], a[132:135], v[180:183], v[12:15]
    s_xor_b32 s36, s68, 131328
    ds_read_b64_tr_b16 a[104:105], v40 offset:8192
    v_cvt_pk_bf16_f32 v33, v34, v35
    v_mfma_f32_16x16x32_bf16 v[12:15], a[128:131], v[176:179], v[12:15]
    s_waitcnt vmcnt(8) lgkmcnt(5)
    ds_read_b64_tr_b16 a[106:107], v40 offset:10240
    v_mul_f32 v36, v36, v3
    v_mfma_f32_16x16x32_bf16 v[8:11], a[128:131], v[168:171], v[8:11]
    s_barrier
    v_mul_f32 v37, v37, v3
    v_mul_f32 v38, v38, v3
    v_mfma_f32_16x16x32_bf16 v[8:11], a[132:135], v[172:175], v[8:11]
    ds_read_b64_tr_b16 a[108:109], v40 offset:12288
    v_mul_f32 v39, v39, v3
    v_mfma_f32_16x16x32_bf16 v[8:11], a[136:139], v[192:195], v[8:11]
    ds_read_b64_tr_b16 a[110:111], v40 offset:14336
    v_cvt_pk_bf16_f32 v36, v36, v37
    v_mfma_f32_16x16x32_bf16 v[8:11], a[140:143], v[196:199], v[8:11]
    buffer_load_dwordx4 v56, s[20:23], s36 offen offset:0 nt lds
    v_mfma_f32_16x16x32_bf16 v[8:11], a[144:147], v[216:219], v[8:11]
    ds_read_b64_tr_b16 a[112:113], v40 offset:16384
    v_cvt_pk_bf16_f32 v37, v38, v39
    v_mfma_f32_16x16x32_bf16 v[8:11], a[148:151], v[220:223], v[8:11]
    ds_read_b64_tr_b16 a[114:115], v40 offset:18432
    v_mul_f32 v12, v12, v3
    v_mfma_f32_16x16x32_bf16 v[8:11], a[152:155], v[240:243], v[8:11]
    v_mul_f32 v13, v13, v3
    v_mul_f32 v14, v14, v3
    v_mfma_f32_16x16x32_bf16 v[8:11], a[156:159], v[244:247], v[8:11]
    ds_read_b64_tr_b16 a[116:117], v40 offset:20480
    v_mul_f32 v15, v15, v3
    v_mfma_f32_16x16x32_bf16 v[4:7], a[156:159], v[236:239], v[4:7]
    ds_read_b64_tr_b16 a[118:119], v40 offset:22528
    v_cvt_pk_bf16_f32 v38, v12, v13
    v_mfma_f32_16x16x32_bf16 v[4:7], a[152:155], v[232:235], v[4:7]
    v_cvt_pk_bf16_f32 v39, v14, v15
    v_mfma_f32_16x16x32_bf16 v[4:7], a[148:151], v[212:215], v[4:7]
    ds_read_b64_tr_b16 a[120:121], v40 offset:24576
    v_mul_f32 v8, v8, v2
    v_mfma_f32_16x16x32_bf16 v[4:7], a[144:147], v[208:211], v[4:7]
    ds_read_b64_tr_b16 a[122:123], v40 offset:26624
    v_mul_f32 v9, v9, v2
    v_mfma_f32_16x16x32_bf16 v[4:7], a[140:143], v[188:191], v[4:7]
    buffer_load_dwordx4 v57, s[20:23], s36 offen offset:1024 nt lds
    v_mfma_f32_16x16x32_bf16 v[4:7], a[136:139], v[184:187], v[4:7]
    ds_read_b64_tr_b16 a[124:125], v40 offset:28672
    v_mul_f32 v10, v10, v2
    v_mfma_f32_16x16x32_bf16 v[4:7], a[132:135], v[164:167], v[4:7]
    ds_read_b64_tr_b16 a[126:127], v40 offset:30720
    v_mul_f32 v11, v11, v2
    v_mfma_f32_16x16x32_bf16 v[4:7], a[128:131], v[160:163], v[4:7]
    s_waitcnt lgkmcnt(5)
    v_permlane16_swap_b32 v36, v38
    v_mfma_f32_16x16x32_bf16 v[16:19], a[96:99], a[164:167], 0
    ds_read_b64_tr_b16 a[156:157], v41 offset:28672
    v_cvt_pk_bf16_f32 v34, v8, v9
    v_mfma_f32_16x16x32_bf16 v[16:19], a[100:103], a[168:171], v[16:19]
    ds_read_b64_tr_b16 a[158:159], v41 offset:30720
    v_cvt_pk_bf16_f32 v35, v10, v11
    v_mfma_f32_16x16x32_bf16 v[16:19], a[104:107], v[88:91], v[16:19]
    v_permlane16_swap_b32 v37, v39
    v_mfma_f32_16x16x32_bf16 v[16:19], a[108:111], v[92:95], v[16:19]
    s_waitcnt lgkmcnt(4)
    ds_read_b64_tr_b16 a[152:153], v41 offset:24576
    v_mul_f32 v4, v4, v1
    v_mfma_f32_16x16x32_bf16 v[16:19], a[112:115], v[112:115], v[16:19]
    s_mov_b64 vcc, s[70:71]
    ds_read_b64_tr_b16 a[154:155], v41 offset:26624
    v_mul_f32 v5, v5, v1
    v_mfma_f32_16x16x32_bf16 v[16:19], a[116:119], v[116:119], v[16:19]
    buffer_load_dwordx4 v58, s[20:23], s36 offen offset:2048 nt lds
    v_mfma_f32_16x16x32_bf16 v[16:19], a[120:123], v[136:139], v[16:19]
    s_waitcnt lgkmcnt(4)
    ds_read_b64_tr_b16 a[148:149], v41 offset:20480
    v_mul_f32 v6, v6, v1
    v_mfma_f32_16x16x32_bf16 v[16:19], a[124:127], v[140:143], v[16:19]
    ds_read_b64_tr_b16 a[150:151], v41 offset:22528
    v_mul_f32 v7, v7, v1
    v_mfma_f32_16x16x32_bf16 v[20:23], a[124:127], v[148:151], 0
    v_permlane16_swap_b32 v32, v34
    v_mfma_f32_16x16x32_bf16 v[20:23], a[120:123], v[144:147], v[20:23]
    ds_read_b64_tr_b16 a[144:145], v41 offset:16384
    v_cvt_pk_bf16_f32 v30, v4, v5
    v_mfma_f32_16x16x32_bf16 v[20:23], a[116:119], v[124:127], v[20:23]
    ds_read_b64_tr_b16 a[146:147], v41 offset:18432
    v_cvt_pk_bf16_f32 v31, v6, v7
    v_mfma_f32_16x16x32_bf16 v[20:23], a[112:115], v[120:123], v[20:23]
    v_permlane16_swap_b32 v33, v35
    v_mfma_f32_16x16x32_bf16 v[20:23], a[108:111], v[100:103], v[20:23]
    ds_read_b64_tr_b16 a[140:141], v41 offset:12288
    v_cndmask_b32_dpp v12, v36, v84, vcc quad_perm:[1,0,3,2] row_mask:0xf bank_mask:0xf
    v_mfma_f32_16x16x32_bf16 v[20:23], a[104:107], v[96:99], v[20:23]
    ds_read_b64_tr_b16 a[142:143], v41 offset:14336
    v_cndmask_b32_dpp v13, v37, v85, vcc quad_perm:[1,0,3,2] row_mask:0xf bank_mask:0xf
    v_mfma_f32_16x16x32_bf16 v[20:23], a[100:103], a[176:179], v[20:23]
    buffer_load_dwordx4 v59, s[20:23], s36 offen offset:3072 nt lds
    v_mfma_f32_16x16x32_bf16 v[20:23], a[96:99], a[172:175], v[20:23]
    ds_read_b64_tr_b16 a[136:137], v41 offset:8192
    v_cndmask_b32_dpp v14, v38, v86, vcc quad_perm:[1,0,3,2] row_mask:0xf bank_mask:0xf
    v_mfma_f32_16x16x32_bf16 v[24:27], a[96:99], a[180:183], 0
    ds_read_b64_tr_b16 a[138:139], v41 offset:10240
    v_cndmask_b32_dpp v15, v39, v87, vcc quad_perm:[1,0,3,2] row_mask:0xf bank_mask:0xf
    v_mfma_f32_16x16x32_bf16 v[24:27], a[100:103], a[184:187], v[24:27]
    s_not_b64 vcc, s[70:71]
    v_permlane16_swap_b32 v28, v30
    v_mfma_f32_16x16x32_bf16 v[24:27], a[104:107], v[104:107], v[24:27]
    ds_read_b64_tr_b16 a[132:133], v41 offset:4096
    v_cndmask_b32_dpp v36, v84, v36, vcc quad_perm:[1,0,3,2] row_mask:0xf bank_mask:0xf
    v_mfma_f32_16x16x32_bf16 v[24:27], a[108:111], v[108:111], v[24:27]
    s_add_u32 m0, s29, 114688
    ds_read_b64_tr_b16 a[134:135], v41 offset:6144
    v_cndmask_b32_dpp v37, v85, v37, vcc quad_perm:[1,0,3,2] row_mask:0xf bank_mask:0xf
    v_mfma_f32_16x16x32_bf16 v[24:27], a[112:115], v[128:131], v[24:27]
    s_xor_b32 s36, s68, 196864
    v_permlane16_swap_b32 v29, v31
    v_mfma_f32_16x16x32_bf16 v[24:27], a[116:119], v[132:135], v[24:27]
    ds_read_b64_tr_b16 a[128:129], v41 offset:0
    v_cndmask_b32_dpp v38, v86, v38, vcc quad_perm:[1,0,3,2] row_mask:0xf bank_mask:0xf
    v_mfma_f32_16x16x32_bf16 v[24:27], a[120:123], v[152:155], v[24:27]
    s_waitcnt lgkmcnt(5)
    ds_read_b64_tr_b16 a[130:131], v41 offset:2048
    v_cndmask_b32_dpp v39, v87, v39, vcc quad_perm:[1,0,3,2] row_mask:0xf bank_mask:0xf
    v_mfma_f32_16x16x32_bf16 v[24:27], a[124:127], v[156:159], v[24:27]
    s_mov_b64 vcc, s[70:71]
    buffer_load_dwordx4 v56, s[20:23], s36 offen offset:0 nt lds
    v_mfma_f32_16x16x32_bf16 v[72:75], a[156:159], v[156:159], 0
    ds_read_b64_tr_b16 a[96:97], v42 offset:0
    v_cndmask_b32_dpp v8, v32, v80, vcc quad_perm:[1,0,3,2] row_mask:0xf bank_mask:0xf
    v_mfma_f32_16x16x32_bf16 v[72:75], a[152:155], v[152:155], v[72:75]
    ds_read_b64_tr_b16 a[98:99], v42 offset:2048
    v_cndmask_b32_dpp v9, v33, v81, vcc quad_perm:[1,0,3,2] row_mask:0xf bank_mask:0xf
    v_mfma_f32_16x16x32_bf16 v[72:75], a[148:151], v[132:135], v[72:75]
    v_cndmask_b32_dpp v10, v34, v82, vcc quad_perm:[1,0,3,2] row_mask:0xf bank_mask:0xf
    v_mfma_f32_16x16x32_bf16 v[72:75], a[144:147], v[128:131], v[72:75]
    s_waitcnt lgkmcnt(4)
    ds_read_b64_tr_b16 a[100:101], v42 offset:4096
    v_cndmask_b32_dpp v11, v35, v83, vcc quad_perm:[1,0,3,2] row_mask:0xf bank_mask:0xf
    v_mfma_f32_16x16x32_bf16 v[72:75], a[140:143], v[108:111], v[72:75]
    s_not_b64 vcc, s[70:71]
    ds_read_b64_tr_b16 a[102:103], v42 offset:6144
    v_cndmask_b32_dpp v32, v80, v32, vcc quad_perm:[1,0,3,2] row_mask:0xf bank_mask:0xf
    v_mfma_f32_16x16x32_bf16 v[72:75], a[136:139], v[104:107], v[72:75]
    v_cndmask_b32_dpp v33, v81, v33, vcc quad_perm:[1,0,3,2] row_mask:0xf bank_mask:0xf
    v_mfma_f32_16x16x32_bf16 v[72:75], a[132:135], a[184:187], v[72:75]
    s_waitcnt lgkmcnt(4)
    ds_read_b64_tr_b16 a[104:105], v42 offset:8192
    v_cndmask_b32_dpp v34, v82, v34, vcc quad_perm:[1,0,3,2] row_mask:0xf bank_mask:0xf
    v_mfma_f32_16x16x32_bf16 v[72:75], a[128:131], a[180:183], v[72:75]
    ds_read_b64_tr_b16 a[106:107], v42 offset:10240
    v_cndmask_b32_dpp v35, v83, v35, vcc quad_perm:[1,0,3,2] row_mask:0xf bank_mask:0xf
    v_mfma_f32_16x16x32_bf16 v[68:71], a[128:131], a[172:175], 0
    s_mov_b64 vcc, s[70:71]
    buffer_load_dwordx4 v57, s[20:23], s36 offen offset:1024 nt lds
    v_mfma_f32_16x16x32_bf16 v[68:71], a[132:135], a[176:179], v[68:71]
    ds_read_b64_tr_b16 a[108:109], v42 offset:12288
    v_cndmask_b32_dpp v4, v28, v76, vcc quad_perm:[1,0,3,2] row_mask:0xf bank_mask:0xf
    v_mfma_f32_16x16x32_bf16 v[68:71], a[136:139], v[96:99], v[68:71]
    ds_read_b64_tr_b16 a[110:111], v42 offset:14336
    v_cndmask_b32_dpp v5, v29, v77, vcc quad_perm:[1,0,3,2] row_mask:0xf bank_mask:0xf
    v_mfma_f32_16x16x32_bf16 v[68:71], a[140:143], v[100:103], v[68:71]
    v_cndmask_b32_dpp v6, v30, v78, vcc quad_perm:[1,0,3,2] row_mask:0xf bank_mask:0xf
    v_mfma_f32_16x16x32_bf16 v[68:71], a[144:147], v[120:123], v[68:71]
    ds_read_b64_tr_b16 a[112:113], v42 offset:16384
    v_cndmask_b32_dpp v7, v31, v79, vcc quad_perm:[1,0,3,2] row_mask:0xf bank_mask:0xf
    v_mfma_f32_16x16x32_bf16 v[68:71], a[148:151], v[124:127], v[68:71]
    s_not_b64 vcc, s[70:71]
    ds_read_b64_tr_b16 a[114:115], v42 offset:18432
    v_cndmask_b32_dpp v28, v76, v28, vcc quad_perm:[1,0,3,2] row_mask:0xf bank_mask:0xf
    v_mfma_f32_16x16x32_bf16 v[68:71], a[152:155], v[144:147], v[68:71]
    v_cndmask_b32_dpp v29, v77, v29, vcc quad_perm:[1,0,3,2] row_mask:0xf bank_mask:0xf
    v_mfma_f32_16x16x32_bf16 v[68:71], a[156:159], v[148:151], v[68:71]
    ds_read_b64_tr_b16 a[116:117], v42 offset:20480
    v_cndmask_b32_dpp v30, v78, v30, vcc quad_perm:[1,0,3,2] row_mask:0xf bank_mask:0xf
    v_mfma_f32_16x16x32_bf16 v[64:67], a[156:159], v[140:143], 0
    ds_read_b64_tr_b16 a[118:119], v42 offset:22528
    v_cndmask_b32_dpp v31, v79, v31, vcc quad_perm:[1,0,3,2] row_mask:0xf bank_mask:0xf
    v_mfma_f32_16x16x32_bf16 v[64:67], a[152:155], v[136:139], v[64:67]
    v_accvgpr_write_b32 a188, v36
    v_mfma_f32_16x16x32_bf16 v[64:67], a[148:151], v[116:119], v[64:67]
    ds_read_b64_tr_b16 a[120:121], v42 offset:24576
    v_accvgpr_write_b32 a189, v37
    v_mfma_f32_16x16x32_bf16 v[64:67], a[144:147], v[112:115], v[64:67]
    ds_read_b64_tr_b16 a[122:123], v42 offset:26624
    v_accvgpr_write_b32 a190, v38
    v_mfma_f32_16x16x32_bf16 v[64:67], a[140:143], v[92:95], v[64:67]
    buffer_load_dwordx4 v58, s[20:23], s36 offen offset:2048 nt lds
    v_mfma_f32_16x16x32_bf16 v[64:67], a[136:139], v[88:91], v[64:67]
    ds_read_b64_tr_b16 a[124:125], v42 offset:28672
    v_accvgpr_write_b32 a191, v39
    v_mfma_f32_16x16x32_bf16 v[64:67], a[132:135], a[168:171], v[64:67]
    ds_read_b64_tr_b16 a[126:127], v42 offset:30720
    v_accvgpr_write_b32 a192, v32
    v_mfma_f32_16x16x32_bf16 v[64:67], a[128:131], a[164:167], v[64:67]
    s_waitcnt lgkmcnt(5)
    v_accvgpr_write_b32 a193, v33
    v_mfma_f32_16x16x32_bf16 v[76:79], a[96:99], a[164:167], 0
    ds_read_b64_tr_b16 a[156:157], v43 offset:28672
    v_accvgpr_write_b32 a194, v34
    v_mfma_f32_16x16x32_bf16 v[76:79], a[100:103], a[168:171], v[76:79]
    ds_read_b64_tr_b16 a[158:159], v43 offset:30720
    v_accvgpr_write_b32 a195, v35
    v_mfma_f32_16x16x32_bf16 v[76:79], a[104:107], v[88:91], v[76:79]
    v_accvgpr_write_b32 a196, v28
    v_mfma_f32_16x16x32_bf16 v[76:79], a[108:111], v[92:95], v[76:79]
    ds_read_b64_tr_b16 a[152:153], v43 offset:24576
    v_accvgpr_write_b32 a197, v29
    v_mfma_f32_16x16x32_bf16 v[76:79], a[112:115], v[112:115], v[76:79]
    s_waitcnt lgkmcnt(5)
    ds_read_b64_tr_b16 a[154:155], v43 offset:26624
    v_accvgpr_write_b32 a198, v30
    v_mfma_f32_16x16x32_bf16 v[76:79], a[116:119], v[116:119], v[76:79]
    buffer_load_dwordx4 v59, s[20:23], s36 offen offset:3072 nt lds
    v_mfma_f32_16x16x32_bf16 v[76:79], a[120:123], v[136:139], v[76:79]
    s_waitcnt lgkmcnt(4)
    ds_read_b64_tr_b16 a[148:149], v43 offset:20480
    v_accvgpr_write_b32 a199, v31
    v_mfma_f32_16x16x32_bf16 v[76:79], a[124:127], v[140:143], v[76:79]
    ds_read_b64_tr_b16 a[150:151], v43 offset:22528
    v_accvgpr_write_b32 a200, v12
    v_mfma_f32_16x16x32_bf16 v[80:83], a[124:127], v[148:151], 0
    v_accvgpr_write_b32 a201, v13
    v_mfma_f32_16x16x32_bf16 v[80:83], a[120:123], v[144:147], v[80:83]
    s_add_u32 m0, s29, 131072
    ds_read_b64_tr_b16 a[144:145], v43 offset:16384
    v_accvgpr_write_b32 a202, v14
    v_mfma_f32_16x16x32_bf16 v[80:83], a[116:119], v[124:127], v[80:83]
    s_xor_b32 s36, s68, 384
    ds_read_b64_tr_b16 a[146:147], v43 offset:18432
    v_accvgpr_write_b32 a203, v15
    v_mfma_f32_16x16x32_bf16 v[80:83], a[112:115], v[120:123], v[80:83]
    v_accvgpr_write_b32 a204, v8
    v_mfma_f32_16x16x32_bf16 v[80:83], a[108:111], v[100:103], v[80:83]
    ds_read_b64_tr_b16 a[140:141], v43 offset:12288
    v_accvgpr_write_b32 a205, v9
    v_mfma_f32_16x16x32_bf16 v[80:83], a[104:107], v[96:99], v[80:83]
    ds_read_b64_tr_b16 a[142:143], v43 offset:14336
    v_accvgpr_write_b32 a206, v10
    v_mfma_f32_16x16x32_bf16 v[80:83], a[100:103], a[176:179], v[80:83]
    buffer_load_dwordx4 v56, s[20:23], s36 offen offset:0 nt lds
    v_mfma_f32_16x16x32_bf16 v[80:83], a[96:99], a[172:175], v[80:83]
    ds_read_b64_tr_b16 a[136:137], v43 offset:8192
    v_accvgpr_write_b32 a207, v11
    v_mfma_f32_16x16x32_bf16 v[84:87], a[96:99], a[180:183], 0
    ds_read_b64_tr_b16 a[138:139], v43 offset:10240
    v_accvgpr_write_b32 a208, v4
    v_mfma_f32_16x16x32_bf16 v[84:87], a[100:103], a[184:187], v[84:87]
    v_accvgpr_write_b32 a209, v5
    v_mfma_f32_16x16x32_bf16 v[84:87], a[104:107], v[104:107], v[84:87]
    ds_read_b64_tr_b16 a[132:133], v43 offset:4096
    v_accvgpr_write_b32 a210, v6
    v_mfma_f32_16x16x32_bf16 v[84:87], a[108:111], v[108:111], v[84:87]
    ds_read_b64_tr_b16 a[134:135], v43 offset:6144
    v_accvgpr_write_b32 a211, v7
    v_mfma_f32_16x16x32_bf16 v[84:87], a[112:115], v[128:131], v[84:87]
    v_mfma_f32_16x16x32_bf16 v[84:87], a[116:119], v[132:135], v[84:87]
    ds_read_b64_tr_b16 a[128:129], v43 offset:0
    v_mfma_f32_16x16x32_bf16 v[84:87], a[120:123], v[152:155], v[84:87]
    ds_read_b64_tr_b16 a[130:131], v43 offset:2048
    v_mfma_f32_16x16x32_bf16 v[84:87], a[124:127], v[156:159], v[84:87]
    s_waitcnt lgkmcnt(5)
    buffer_load_dwordx4 v57, s[20:23], s36 offen offset:1024 nt lds
    v_mfma_f32_16x16x32_bf16 v[36:39], a[156:159], v[156:159], 0
    ds_read_b64_tr_b16 a[96:97], v40 offset:32768
    v_mfma_f32_16x16x32_bf16 v[36:39], a[152:155], v[152:155], v[36:39]
    ds_read_b64_tr_b16 a[98:99], v40 offset:34816
    v_mfma_f32_16x16x32_bf16 v[36:39], a[148:151], v[132:135], v[36:39]
    v_mfma_f32_16x16x32_bf16 v[36:39], a[144:147], v[128:131], v[36:39]
    ds_read_b64_tr_b16 a[100:101], v40 offset:36864
    v_mfma_f32_16x16x32_bf16 v[36:39], a[140:143], v[108:111], v[36:39]
    s_waitcnt lgkmcnt(5)
    ds_read_b64_tr_b16 a[102:103], v40 offset:38912
    v_mfma_f32_16x16x32_bf16 v[36:39], a[136:139], v[104:107], v[36:39]
    v_mfma_f32_16x16x32_bf16 v[36:39], a[132:135], a[184:187], v[36:39]
    s_waitcnt lgkmcnt(4)
    ds_read_b64_tr_b16 a[104:105], v40 offset:40960
    v_mfma_f32_16x16x32_bf16 v[36:39], a[128:131], a[180:183], v[36:39]
    s_waitcnt vmcnt(10) lgkmcnt(5)
    ds_read_b64_tr_b16 a[106:107], v40 offset:43008
    v_mfma_f32_16x16x32_bf16 v[32:35], a[128:131], a[172:175], 0
    s_barrier
    buffer_load_dwordx4 v58, s[20:23], s36 offen offset:2048 nt lds
    v_mfma_f32_16x16x32_bf16 v[32:35], a[132:135], a[176:179], v[32:35]
    ds_read_b64_tr_b16 a[108:109], v40 offset:45056
    v_mfma_f32_16x16x32_bf16 v[32:35], a[136:139], v[96:99], v[32:35]
    ds_read_b64_tr_b16 a[110:111], v40 offset:47104
    v_mfma_f32_16x16x32_bf16 v[32:35], a[140:143], v[100:103], v[32:35]
    v_mfma_f32_16x16x32_bf16 v[32:35], a[144:147], v[120:123], v[32:35]
    ds_read_b64_tr_b16 a[112:113], v40 offset:49152
    v_mfma_f32_16x16x32_bf16 v[32:35], a[148:151], v[124:127], v[32:35]
    ds_read_b64_tr_b16 a[114:115], v40 offset:51200
    v_mfma_f32_16x16x32_bf16 v[32:35], a[152:155], v[144:147], v[32:35]
    v_mfma_f32_16x16x32_bf16 v[32:35], a[156:159], v[148:151], v[32:35]
    ds_read_b64_tr_b16 a[116:117], v40 offset:53248
    v_mfma_f32_16x16x32_bf16 v[28:31], a[156:159], v[140:143], 0
    ds_read_b64_tr_b16 a[118:119], v40 offset:55296
    v_mfma_f32_16x16x32_bf16 v[28:31], a[152:155], v[136:139], v[28:31]
    buffer_load_dwordx4 v59, s[20:23], s36 offen offset:3072 nt lds
    v_mfma_f32_16x16x32_bf16 v[28:31], a[148:151], v[116:119], v[28:31]
    ds_read_b64_tr_b16 a[120:121], v40 offset:57344
    v_mfma_f32_16x16x32_bf16 v[28:31], a[144:147], v[112:115], v[28:31]
    ds_read_b64_tr_b16 a[122:123], v40 offset:59392
    v_mfma_f32_16x16x32_bf16 v[28:31], a[140:143], v[92:95], v[28:31]
    v_mfma_f32_16x16x32_bf16 v[28:31], a[136:139], v[88:91], v[28:31]
    ds_read_b64_tr_b16 a[124:125], v40 offset:61440
    v_mfma_f32_16x16x32_bf16 v[28:31], a[132:135], a[168:171], v[28:31]
    s_waitcnt lgkmcnt(5)
    ds_read_b64_tr_b16 a[126:127], v40 offset:63488
    v_mfma_f32_16x16x32_bf16 v[28:31], a[128:131], a[164:167], v[28:31]
    s_add_u32 m0, s29, 147456
    v_mfma_f32_16x16x32_bf16 v[16:19], a[96:99], v[160:163], v[16:19]
    s_xor_b32 s36, s68, 65920
    ds_read_b64_tr_b16 a[156:157], v41 offset:61440
    v_mfma_f32_16x16x32_bf16 v[16:19], a[100:103], v[164:167], v[16:19]
    ds_read_b64_tr_b16 a[158:159], v41 offset:63488
    v_mfma_f32_16x16x32_bf16 v[16:19], a[104:107], v[184:187], v[16:19]
    v_mfma_f32_16x16x32_bf16 v[16:19], a[108:111], v[188:191], v[16:19]
    ds_read_b64_tr_b16 a[152:153], v41 offset:57344
    v_mfma_f32_16x16x32_bf16 v[16:19], a[112:115], v[208:211], v[16:19]
    s_waitcnt lgkmcnt(5)
    ds_read_b64_tr_b16 a[154:155], v41 offset:59392
    v_mfma_f32_16x16x32_bf16 v[16:19], a[116:119], v[212:215], v[16:19]
    buffer_load_dwordx4 v56, s[20:23], s36 offen offset:0 nt lds
    v_mfma_f32_16x16x32_bf16 v[16:19], a[120:123], v[232:235], v[16:19]
    s_waitcnt lgkmcnt(4)
    ds_read_b64_tr_b16 a[148:149], v41 offset:53248
    v_mfma_f32_16x16x32_bf16 v[16:19], a[124:127], v[236:239], v[16:19]
    ds_read_b64_tr_b16 a[150:151], v41 offset:55296
    v_mfma_f32_16x16x32_bf16 v[20:23], a[124:127], v[244:247], v[20:23]
    v_mfma_f32_16x16x32_bf16 v[20:23], a[120:123], v[240:243], v[20:23]
    ds_read_b64_tr_b16 a[144:145], v41 offset:49152
    v_mfma_f32_16x16x32_bf16 v[20:23], a[116:119], v[220:223], v[20:23]
    ds_read_b64_tr_b16 a[146:147], v41 offset:51200
    v_mfma_f32_16x16x32_bf16 v[20:23], a[112:115], v[216:219], v[20:23]
    v_mfma_f32_16x16x32_bf16 v[20:23], a[108:111], v[196:199], v[20:23]
    ds_read_b64_tr_b16 a[140:141], v41 offset:45056
    v_mul_f32 v16, v16, v1
    v_mfma_f32_16x16x32_bf16 v[20:23], a[104:107], v[192:195], v[20:23]
    ds_read_b64_tr_b16 a[142:143], v41 offset:47104
    v_mul_f32 v17, v17, v1
    v_mfma_f32_16x16x32_bf16 v[20:23], a[100:103], v[172:175], v[20:23]
    buffer_load_dwordx4 v57, s[20:23], s36 offen offset:1024 nt lds
    v_mfma_f32_16x16x32_bf16 v[20:23], a[96:99], v[168:171], v[20:23]
    ds_read_b64_tr_b16 a[136:137], v41 offset:40960
    v_mul_f32 v18, v18, v1
    v_mfma_f32_16x16x32_bf16 v[24:27], a[96:99], v[176:179], v[24:27]
    ds_read_b64_tr_b16 a[138:139], v41 offset:43008
    v_mul_f32 v19, v19, v1
    v_mfma_f32_16x16x32_bf16 v[24:27], a[100:103], v[180:183], v[24:27]
    v_mfma_f32_16x16x32_bf16 v[24:27], a[104:107], v[200:203], v[24:27]
    ds_read_b64_tr_b16 a[132:133], v41 offset:36864
    v_mfma_f32_16x16x32_bf16 v[24:27], a[108:111], v[204:207], v[24:27]
    ds_read_b64_tr_b16 a[134:135], v41 offset:38912
    v_mul_f32 v20, v20, v2
    v_mfma_f32_16x16x32_bf16 v[24:27], a[112:115], v[224:227], v[24:27]
    v_mul_f32 v21, v21, v2
    v_mul_f32 v22, v22, v2
    v_mfma_f32_16x16x32_bf16 v[24:27], a[116:119], v[228:231], v[24:27]
    ds_read_b64_tr_b16 a[128:129], v41 offset:32768
    v_mul_f32 v23, v23, v2
    v_mfma_f32_16x16x32_bf16 v[24:27], a[120:123], v[248:251], v[24:27]
    ds_read_b64_tr_b16 a[130:131], v41 offset:34816
    v_mfma_f32_16x16x32_bf16 v[24:27], a[124:127], v[252:255], v[24:27]
    s_waitcnt lgkmcnt(5)
    buffer_load_dwordx4 v58, s[20:23], s36 offen offset:2048 nt lds
    v_mfma_f32_16x16x32_bf16 v[72:75], a[156:159], v[252:255], v[72:75]
    ds_read_b64_tr_b16 a[96:97], v42 offset:32768
    v_mfma_f32_16x16x32_bf16 v[72:75], a[152:155], v[248:251], v[72:75]
    ds_read_b64_tr_b16 a[98:99], v42 offset:34816
    v_mfma_f32_16x16x32_bf16 v[72:75], a[148:151], v[228:231], v[72:75]
    v_mfma_f32_16x16x32_bf16 v[72:75], a[144:147], v[224:227], v[72:75]
    ds_read_b64_tr_b16 a[100:101], v42 offset:36864
    v_mfma_f32_16x16x32_bf16 v[72:75], a[140:143], v[204:207], v[72:75]
    s_waitcnt lgkmcnt(5)
    ds_read_b64_tr_b16 a[102:103], v42 offset:38912
    v_mul_f32 v24, v24, v3
    v_mfma_f32_16x16x32_bf16 v[72:75], a[136:139], v[200:203], v[72:75]
    v_mul_f32 v25, v25, v3
    v_mul_f32 v26, v26, v3
    v_mfma_f32_16x16x32_bf16 v[72:75], a[132:135], v[180:183], v[72:75]
    s_waitcnt lgkmcnt(4)
    ds_read_b64_tr_b16 a[104:105], v42 offset:40960
    v_mul_f32 v27, v27, v3
    v_mfma_f32_16x16x32_bf16 v[72:75], a[128:131], v[176:179], v[72:75]
    ds_read_b64_tr_b16 a[106:107], v42 offset:43008
    v_mfma_f32_16x16x32_bf16 v[68:71], a[128:131], v[168:171], v[68:71]
    buffer_load_dwordx4 v59, s[20:23], s36 offen offset:3072 nt lds
    v_mfma_f32_16x16x32_bf16 v[68:71], a[132:135], v[172:175], v[68:71]
    ds_read_b64_tr_b16 a[108:109], v42 offset:45056
    v_mfma_f32_16x16x32_bf16 v[68:71], a[136:139], v[192:195], v[68:71]
    ds_read_b64_tr_b16 a[110:111], v42 offset:47104
    v_mfma_f32_16x16x32_bf16 v[68:71], a[140:143], v[196:199], v[68:71]
    v_mul_f32 v72, v72, v3
    v_mul_f32 v73, v73, v3
    v_mfma_f32_16x16x32_bf16 v[68:71], a[144:147], v[216:219], v[68:71]
    ds_read_b64_tr_b16 a[112:113], v42 offset:49152
    v_mul_f32 v74, v74, v3
    v_mfma_f32_16x16x32_bf16 v[68:71], a[148:151], v[220:223], v[68:71]
    s_add_u32 m0, s29, 0
    ds_read_b64_tr_b16 a[114:115], v42 offset:51200
    v_mul_f32 v75, v75, v3
    v_mfma_f32_16x16x32_bf16 v[68:71], a[152:155], v[240:243], v[68:71]
    s_xor_b32 s36, s68, 131456
    v_cvt_pk_bf16_f32 v75, v74, v75
    v_mfma_f32_16x16x32_bf16 v[68:71], a[156:159], v[244:247], v[68:71]
    ds_read_b64_tr_b16 a[116:117], v42 offset:53248
    v_cvt_pk_bf16_f32 v74, v72, v73
    v_mfma_f32_16x16x32_bf16 v[64:67], a[156:159], v[236:239], v[64:67]
    ds_read_b64_tr_b16 a[118:119], v42 offset:55296
    v_cvt_pk_bf16_f32 v72, v24, v25
    v_mfma_f32_16x16x32_bf16 v[64:67], a[152:155], v[232:235], v[64:67]
    buffer_load_dwordx4 v56, s[20:23], s36 offen offset:0 nt lds
    v_mfma_f32_16x16x32_bf16 v[64:67], a[148:151], v[212:215], v[64:67]
    ds_read_b64_tr_b16 a[120:121], v42 offset:57344
    v_cvt_pk_bf16_f32 v73, v26, v27
    v_mfma_f32_16x16x32_bf16 v[64:67], a[144:147], v[208:211], v[64:67]
    ds_read_b64_tr_b16 a[122:123], v42 offset:59392
    v_mul_f32 v68, v68, v2
    v_mfma_f32_16x16x32_bf16 v[64:67], a[140:143], v[188:191], v[64:67]
    v_permlane16_swap_b32 v72, v74
    v_mfma_f32_16x16x32_bf16 v[64:67], a[136:139], v[184:187], v[64:67]
    ds_read_b64_tr_b16 a[124:125], v42 offset:61440
    v_mul_f32 v69, v69, v2
    v_mfma_f32_16x16x32_bf16 v[64:67], a[132:135], v[164:167], v[64:67]
    ds_read_b64_tr_b16 a[126:127], v42 offset:63488
    v_mul_f32 v70, v70, v2
    v_mfma_f32_16x16x32_bf16 v[64:67], a[128:131], v[160:163], v[64:67]
    s_waitcnt lgkmcnt(5)
    v_permlane16_swap_b32 v73, v75
    v_mfma_f32_16x16x32_bf16 v[76:79], a[96:99], v[160:163], v[76:79]
    ds_read_b64_tr_b16 a[156:157], v43 offset:61440
    v_mul_f32 v71, v71, v2
    v_mfma_f32_16x16x32_bf16 v[76:79], a[100:103], v[164:167], v[76:79]
    ds_read_b64_tr_b16 a[158:159], v43 offset:63488
    v_cvt_pk_bf16_f32 v71, v70, v71
    v_mfma_f32_16x16x32_bf16 v[76:79], a[104:107], v[184:187], v[76:79]
    buffer_load_dwordx4 v57, s[20:23], s36 offen offset:1024 nt lds
    v_mfma_f32_16x16x32_bf16 v[76:79], a[108:111], v[188:191], v[76:79]
    ds_read_b64_tr_b16 a[152:153], v43 offset:57344
    v_cvt_pk_bf16_f32 v70, v68, v69
    v_mfma_f32_16x16x32_bf16 v[76:79], a[112:115], v[208:211], v[76:79]
    s_waitcnt lgkmcnt(5)
    ds_read_b64_tr_b16 a[154:155], v43 offset:59392
    v_cvt_pk_bf16_f32 v68, v20, v21
    v_mfma_f32_16x16x32_bf16 v[76:79], a[116:119], v[212:215], v[76:79]
    v_cvt_pk_bf16_f32 v69, v22, v23
    v_mul_f32 v64, v64, v1
    v_mfma_f32_16x16x32_bf16 v[76:79], a[120:123], v[232:235], v[76:79]
    s_waitcnt lgkmcnt(4)
    ds_read_b64_tr_b16 a[148:149], v43 offset:53248
    v_mul_f32 v65, v65, v1
    v_mfma_f32_16x16x32_bf16 v[76:79], a[124:127], v[236:239], v[76:79]
    ds_read_b64_tr_b16 a[150:151], v43 offset:55296
    v_mul_f32 v66, v66, v1
    v_mfma_f32_16x16x32_bf16 v[80:83], a[124:127], v[244:247], v[80:83]
    v_permlane16_swap_b32 v68, v70
    v_mfma_f32_16x16x32_bf16 v[80:83], a[120:123], v[240:243], v[80:83]
    ds_read_b64_tr_b16 a[144:145], v43 offset:49152
    v_mul_f32 v67, v67, v1
    v_mfma_f32_16x16x32_bf16 v[80:83], a[116:119], v[220:223], v[80:83]
    ds_read_b64_tr_b16 a[146:147], v43 offset:51200
    v_cvt_pk_bf16_f32 v67, v66, v67
    v_mfma_f32_16x16x32_bf16 v[80:83], a[112:115], v[216:219], v[80:83]
    v_permlane16_swap_b32 v69, v71
    v_mfma_f32_16x16x32_bf16 v[80:83], a[108:111], v[196:199], v[80:83]
    ds_read_b64_tr_b16 a[140:141], v43 offset:45056
    v_cvt_pk_bf16_f32 v66, v64, v65
    v_mfma_f32_16x16x32_bf16 v[80:83], a[104:107], v[192:195], v[80:83]
    ds_read_b64_tr_b16 a[142:143], v43 offset:47104
    v_cvt_pk_bf16_f32 v64, v16, v17
    v_mfma_f32_16x16x32_bf16 v[80:83], a[100:103], v[172:175], v[80:83]
    buffer_load_dwordx4 v58, s[20:23], s36 offen offset:2048 nt lds
    v_mfma_f32_16x16x32_bf16 v[80:83], a[96:99], v[168:171], v[80:83]
    ds_read_b64_tr_b16 a[136:137], v43 offset:40960
    v_cvt_pk_bf16_f32 v65, v18, v19
    v_mfma_f32_16x16x32_bf16 v[84:87], a[96:99], v[176:179], v[84:87]
    ds_read_b64_tr_b16 a[138:139], v43 offset:43008
    v_mul_f32 v76, v76, v1
    v_mfma_f32_16x16x32_bf16 v[84:87], a[100:103], v[180:183], v[84:87]
    v_permlane16_swap_b32 v64, v66
    v_mfma_f32_16x16x32_bf16 v[84:87], a[104:107], v[200:203], v[84:87]
L_pad5:
    s_cbranch_execz L_back
    ds_read_b64_tr_b16 a[132:133], v43 offset:36864
    v_mul_f32 v77, v77, v1
    v_mfma_f32_16x16x32_bf16 v[84:87], a[108:111], v[204:207], v[84:87]
    ds_read_b64_tr_b16 a[134:135], v43 offset:38912
    v_mul_f32 v78, v78, v1
    v_mfma_f32_16x16x32_bf16 v[84:87], a[112:115], v[224:227], v[84:87]
    v_permlane16_swap_b32 v65, v67
    v_mfma_f32_16x16x32_bf16 v[84:87], a[116:119], v[228:231], v[84:87]
    ds_read_b64_tr_b16 a[128:129], v43 offset:32768
    v_mul_f32 v79, v79, v1
    v_mfma_f32_16x16x32_bf16 v[84:87], a[120:123], v[248:251], v[84:87]
    ds_read_b64_tr_b16 a[130:131], v43 offset:34816
    v_cvt_pk_bf16_f32 v76, v76, v77
    v_mfma_f32_16x16x32_bf16 v[84:87], a[124:127], v[252:255], v[84:87]
    s_waitcnt lgkmcnt(5)
    buffer_load_dwordx4 v59, s[20:23], s36 offen offset:3072 nt lds
    v_mfma_f32_16x16x32_bf16 v[36:39], a[156:159], v[252:255], v[36:39]
    ds_read_b64_tr_b16 a[96:97], v44 offset:0
    v_cvt_pk_bf16_f32 v77, v78, v79
    v_mfma_f32_16x16x32_bf16 v[36:39], a[152:155], v[248:251], v[36:39]
    ds_read_b64_tr_b16 a[98:99], v44 offset:2048
    v_mul_f32 v80, v80, v2
    v_mfma_f32_16x16x32_bf16 v[36:39], a[148:151], v[228:231], v[36:39]
    s_waitcnt lgkmcnt(5)
    v_mul_f32 v81, v81, v2
    v_mul_f32 v82, v82, v2
    v_mfma_f32_16x16x32_bf16 v[36:39], a[144:147], v[224:227], v[36:39]
    s_add_u32 m0, s29, 16384
    ds_read_b64_tr_b16 a[100:101], v44 offset:4096
    v_mul_f32 v83, v83, v2
    v_mfma_f32_16x16x32_bf16 v[36:39], a[140:143], v[204:207], v[36:39]
    s_xor_b32 s36, s68, 196992
    ds_read_b64_tr_b16 a[102:103], v44 offset:6144
    v_cvt_pk_bf16_f32 v80, v80, v81
    v_mfma_f32_16x16x32_bf16 v[36:39], a[136:139], v[200:203], v[36:39]
    s_waitcnt lgkmcnt(5)
    v_cvt_pk_bf16_f32 v81, v82, v83
    v_mul_f32 v84, v84, v3
    v_mfma_f32_16x16x32_bf16 v[36:39], a[132:135], v[180:183], v[36:39]
    s_waitcnt lgkmcnt(4)
    ds_read_b64_tr_b16 a[104:105], v44 offset:8192
    v_mul_f32 v85, v85, v3
    v_mfma_f32_16x16x32_bf16 v[36:39], a[128:131], v[176:179], v[36:39]
    ds_read_b64_tr_b16 a[106:107], v44 offset:10240
    v_mul_f32 v86, v86, v3
    v_mfma_f32_16x16x32_bf16 v[32:35], a[128:131], v[168:171], v[32:35]
    buffer_load_dwordx4 v56, s[20:23], s36 offen offset:0 nt lds
    v_mfma_f32_16x16x32_bf16 v[32:35], a[132:135], v[172:175], v[32:35]
    ds_read_b64_tr_b16 a[108:109], v44 offset:12288
    v_mul_f32 v87, v87, v3
    v_mfma_f32_16x16x32_bf16 v[32:35], a[136:139], v[192:195], v[32:35]
    ds_read_b64_tr_b16 a[110:111], v44 offset:14336
    v_cvt_pk_bf16_f32 v84, v84, v85
    v_mfma_f32_16x16x32_bf16 v[32:35], a[140:143], v[196:199], v[32:35]
    v_cvt_pk_bf16_f32 v85, v86, v87
    v_mul_f32 v36, v36, v3
    v_mfma_f32_16x16x32_bf16 v[32:35], a[144:147], v[216:219], v[32:35]
    ds_read_b64_tr_b16 a[112:113], v44 offset:16384
    v_mul_f32 v37, v37, v3
    v_mfma_f32_16x16x32_bf16 v[32:35], a[148:151], v[220:223], v[32:35]
    ds_read_b64_tr_b16 a[114:115], v44 offset:18432
    v_mul_f32 v38, v38, v3
    v_mfma_f32_16x16x32_bf16 v[32:35], a[152:155], v[240:243], v[32:35]
    v_mul_f32 v39, v39, v3
    v_cvt_pk_bf16_f32 v86, v36, v37
    v_mfma_f32_16x16x32_bf16 v[32:35], a[156:159], v[244:247], v[32:35]
    ds_read_b64_tr_b16 a[116:117], v44 offset:20480
    v_cvt_pk_bf16_f32 v87, v38, v39
    v_mfma_f32_16x16x32_bf16 v[28:31], a[156:159], v[236:239], v[28:31]
    ds_read_b64_tr_b16 a[118:119], v44 offset:22528
    v_mfma_f32_16x16x32_bf16 v[28:31], a[152:155], v[232:235], v[28:31]
    buffer_load_dwordx4 v57, s[20:23], s36 offen offset:1024 nt lds
    v_mfma_f32_16x16x32_bf16 v[28:31], a[148:151], v[212:215], v[28:31]
    ds_read_b64_tr_b16 a[120:121], v44 offset:24576
    v_mfma_f32_16x16x32_bf16 v[28:31], a[144:147], v[208:211], v[28:31]
    ds_read_b64_tr_b16 a[122:123], v44 offset:26624
    v_mul_f32 v32, v32, v2
    v_mfma_f32_16x16x32_bf16 v[28:31], a[140:143], v[188:191], v[28:31]
    v_permlane16_swap_b32 v84, v86
    v_mfma_f32_16x16x32_bf16 v[28:31], a[136:139], v[184:187], v[28:31]
    ds_read_b64_tr_b16 a[124:125], v44 offset:28672
    v_mul_f32 v33, v33, v2
    v_mfma_f32_16x16x32_bf16 v[28:31], a[132:135], v[164:167], v[28:31]
    ds_read_b64_tr_b16 a[126:127], v44 offset:30720
    v_mul_f32 v34, v34, v2
    v_mfma_f32_16x16x32_bf16 v[28:31], a[128:131], v[160:163], v[28:31]
    s_waitcnt lgkmcnt(5)
    v_permlane16_swap_b32 v85, v87
    v_mfma_f32_16x16x32_bf16 v[4:7], a[96:99], a[164:167], 0
    ds_read_b64_tr_b16 a[156:157], v45 offset:28672
    v_mul_f32 v35, v35, v2
    v_mfma_f32_16x16x32_bf16 v[4:7], a[100:103], a[168:171], v[4:7]
    s_mov_b64 vcc, s[70:71]
    ds_read_b64_tr_b16 a[158:159], v45 offset:30720
    v_cvt_pk_bf16_f32 v82, v32, v33
    v_mfma_f32_16x16x32_bf16 v[4:7], a[104:107], v[88:91], v[4:7]
    buffer_load_dwordx4 v58, s[20:23], s36 offen offset:2048 nt lds
    v_mfma_f32_16x16x32_bf16 v[4:7], a[108:111], v[92:95], v[4:7]
    ds_read_b64_tr_b16 a[152:153], v45 offset:24576
    v_cvt_pk_bf16_f32 v83, v34, v35
    v_mfma_f32_16x16x32_bf16 v[4:7], a[112:115], v[112:115], v[4:7]
    s_waitcnt lgkmcnt(5)
    ds_read_b64_tr_b16 a[154:155], v45 offset:26624
    v_mul_f32 v28, v28, v1
    v_mfma_f32_16x16x32_bf16 v[4:7], a[116:119], v[116:119], v[4:7]
    v_permlane16_swap_b32 v80, v82
    v_mfma_f32_16x16x32_bf16 v[4:7], a[120:123], v[136:139], v[4:7]
    s_waitcnt lgkmcnt(4)
    ds_read_b64_tr_b16 a[148:149], v45 offset:20480
    v_mul_f32 v29, v29, v1
    v_mfma_f32_16x16x32_bf16 v[4:7], a[124:127], v[140:143], v[4:7]
    ds_read_b64_tr_b16 a[150:151], v45 offset:22528
    v_mul_f32 v30, v30, v1
    v_mfma_f32_16x16x32_bf16 v[8:11], a[124:127], v[148:151], 0
    v_permlane16_swap_b32 v81, v83
    v_mfma_f32_16x16x32_bf16 v[8:11], a[120:123], v[144:147], v[8:11]
    ds_read_b64_tr_b16 a[144:145], v45 offset:16384
    v_mul_f32 v31, v31, v1
    v_mfma_f32_16x16x32_bf16 v[8:11], a[116:119], v[124:127], v[8:11]
    ds_read_b64_tr_b16 a[146:147], v45 offset:18432
    v_cvt_pk_bf16_f32 v78, v28, v29
    v_mfma_f32_16x16x32_bf16 v[8:11], a[112:115], v[120:123], v[8:11]
    buffer_load_dwordx4 v59, s[20:23], s36 offen offset:3072 nt lds
    v_mfma_f32_16x16x32_bf16 v[8:11], a[108:111], v[100:103], v[8:11]
    ds_read_b64_tr_b16 a[140:141], v45 offset:12288
    v_cvt_pk_bf16_f32 v79, v30, v31
    v_mfma_f32_16x16x32_bf16 v[8:11], a[104:107], v[96:99], v[8:11]
    ds_read_b64_tr_b16 a[142:143], v45 offset:14336
    v_cndmask_b32_dpp v36, v84, v72, vcc quad_perm:[1,0,3,2] row_mask:0xf bank_mask:0xf
    v_mfma_f32_16x16x32_bf16 v[8:11], a[100:103], a[176:179], v[8:11]
    v_permlane16_swap_b32 v76, v78
    v_mfma_f32_16x16x32_bf16 v[8:11], a[96:99], a[172:175], v[8:11]
    ds_read_b64_tr_b16 a[136:137], v45 offset:8192
    v_cndmask_b32_dpp v37, v85, v73, vcc quad_perm:[1,0,3,2] row_mask:0xf bank_mask:0xf
    v_mfma_f32_16x16x32_bf16 v[12:15], a[96:99], a[180:183], 0
    ds_read_b64_tr_b16 a[138:139], v45 offset:10240
    v_cndmask_b32_dpp v38, v86, v74, vcc quad_perm:[1,0,3,2] row_mask:0xf bank_mask:0xf
    v_mfma_f32_16x16x32_bf16 v[12:15], a[100:103], a[184:187], v[12:15]
    v_permlane16_swap_b32 v77, v79
    v_mfma_f32_16x16x32_bf16 v[12:15], a[104:107], v[104:107], v[12:15]
    ds_read_b64_tr_b16 a[132:133], v45 offset:4096
    v_cndmask_b32_dpp v39, v87, v75, vcc quad_perm:[1,0,3,2] row_mask:0xf bank_mask:0xf
    v_mfma_f32_16x16x32_bf16 v[12:15], a[108:111], v[108:111], v[12:15]
    s_not_b64 vcc, s[70:71]
    ds_read_b64_tr_b16 a[134:135], v45 offset:6144
    v_cndmask_b32_dpp v84, v72, v84, vcc quad_perm:[1,0,3,2] row_mask:0xf bank_mask:0xf
    v_mfma_f32_16x16x32_bf16 v[12:15], a[112:115], v[128:131], v[12:15]
    v_cndmask_b32_dpp v85, v73, v85, vcc quad_perm:[1,0,3,2] row_mask:0xf bank_mask:0xf
    v_mfma_f32_16x16x32_bf16 v[12:15], a[116:119], v[132:135], v[12:15]
    ds_read_b64_tr_b16 a[128:129], v45 offset:0
    v_cndmask_b32_dpp v86, v74, v86, vcc quad_perm:[1,0,3,2] row_mask:0xf bank_mask:0xf
    v_mfma_f32_16x16x32_bf16 v[12:15], a[120:123], v[152:155], v[12:15]
    s_waitcnt lgkmcnt(5)
    ds_read_b64_tr_b16 a[130:131], v45 offset:2048
    v_cndmask_b32_dpp v87, v75, v87, vcc quad_perm:[1,0,3,2] row_mask:0xf bank_mask:0xf
    v_mfma_f32_16x16x32_bf16 v[12:15], a[124:127], v[156:159], v[12:15]
    s_mov_b64 vcc, s[70:71]
    v_cndmask_b32_dpp v32, v80, v68, vcc quad_perm:[1,0,3,2] row_mask:0xf bank_mask:0xf
    v_mfma_f32_16x16x32_bf16 v[24:27], a[156:159], v[156:159], 0
    ds_read_b64_tr_b16 a[96:97], v46 offset:0
    v_cndmask_b32_dpp v33, v81, v69, vcc quad_perm:[1,0,3,2] row_mask:0xf bank_mask:0xf
    v_mfma_f32_16x16x32_bf16 v[24:27], a[152:155], v[152:155], v[24:27]
    ds_read_b64_tr_b16 a[98:99], v46 offset:2048
    v_cndmask_b32_dpp v34, v82, v70, vcc quad_perm:[1,0,3,2] row_mask:0xf bank_mask:0xf
    v_mfma_f32_16x16x32_bf16 v[24:27], a[148:151], v[132:135], v[24:27]
    v_cndmask_b32_dpp v35, v83, v71, vcc quad_perm:[1,0,3,2] row_mask:0xf bank_mask:0xf
    v_mfma_f32_16x16x32_bf16 v[24:27], a[144:147], v[128:131], v[24:27]
    s_not_b64 vcc, s[70:71]
    ds_read_b64_tr_b16 a[100:101], v46 offset:4096
    v_cndmask_b32_dpp v80, v68, v80, vcc quad_perm:[1,0,3,2] row_mask:0xf bank_mask:0xf
    v_mfma_f32_16x16x32_bf16 v[24:27], a[140:143], v[108:111], v[24:27]
    s_waitcnt lgkmcnt(5)
    ds_read_b64_tr_b16 a[102:103], v46 offset:6144
    v_cndmask_b32_dpp v81, v69, v81, vcc quad_perm:[1,0,3,2] row_mask:0xf bank_mask:0xf
    v_mfma_f32_16x16x32_bf16 v[24:27], a[136:139], v[104:107], v[24:27]
    v_cndmask_b32_dpp v82, v70, v82, vcc quad_perm:[1,0,3,2] row_mask:0xf bank_mask:0xf
    v_mfma_f32_16x16x32_bf16 v[24:27], a[132:135], a[184:187], v[24:27]
    s_waitcnt lgkmcnt(4)
    ds_read_b64_tr_b16 a[104:105], v46 offset:8192
    v_cndmask_b32_dpp v83, v71, v83, vcc quad_perm:[1,0,3,2] row_mask:0xf bank_mask:0xf
    v_mfma_f32_16x16x32_bf16 v[24:27], a[128:131], a[180:183], v[24:27]
    s_mov_b64 vcc, s[70:71]
    ds_read_b64_tr_b16 a[106:107], v46 offset:10240
    v_cndmask_b32_dpp v28, v76, v64, vcc quad_perm:[1,0,3,2] row_mask:0xf bank_mask:0xf
    v_mfma_f32_16x16x32_bf16 v[20:23], a[128:131], a[172:175], 0
    v_cndmask_b32_dpp v29, v77, v65, vcc quad_perm:[1,0,3,2] row_mask:0xf bank_mask:0xf
    v_mfma_f32_16x16x32_bf16 v[20:23], a[132:135], a[176:179], v[20:23]
    ds_read_b64_tr_b16 a[108:109], v46 offset:12288
    v_cndmask_b32_dpp v30, v78, v66, vcc quad_perm:[1,0,3,2] row_mask:0xf bank_mask:0xf
    v_mfma_f32_16x16x32_bf16 v[20:23], a[136:139], v[96:99], v[20:23]
    ds_read_b64_tr_b16 a[110:111], v46 offset:14336
    v_cndmask_b32_dpp v31, v79, v67, vcc quad_perm:[1,0,3,2] row_mask:0xf bank_mask:0xf
    v_mfma_f32_16x16x32_bf16 v[20:23], a[140:143], v[100:103], v[20:23]
    s_not_b64 vcc, s[70:71]
    v_cndmask_b32_dpp v76, v64, v76, vcc quad_perm:[1,0,3,2] row_mask:0xf bank_mask:0xf
    v_mfma_f32_16x16x32_bf16 v[20:23], a[144:147], v[120:123], v[20:23]
    ds_read_b64_tr_b16 a[112:113], v46 offset:16384
    v_cndmask_b32_dpp v77, v65, v77, vcc quad_perm:[1,0,3,2] row_mask:0xf bank_mask:0xf
    v_mfma_f32_16x16x32_bf16 v[20:23], a[148:151], v[124:127], v[20:23]
    ds_read_b64_tr_b16 a[114:115], v46 offset:18432
    v_cndmask_b32_dpp v78, v66, v78, vcc quad_perm:[1,0,3,2] row_mask:0xf bank_mask:0xf
    v_mfma_f32_16x16x32_bf16 v[20:23], a[152:155], v[144:147], v[20:23]
    v_cndmask_b32_dpp v79, v67, v79, vcc quad_perm:[1,0,3,2] row_mask:0xf bank_mask:0xf
    v_mfma_f32_16x16x32_bf16 v[20:23], a[156:159], v[148:151], v[20:23]
    ds_read_b64_tr_b16 a[116:117], v46 offset:20480
    v_accvgpr_write_b32 a212, v84
    v_mfma_f32_16x16x32_bf16 v[16:19], a[156:159], v[140:143], 0
    ds_read_b64_tr_b16 a[118:119], v46 offset:22528
    v_accvgpr_write_b32 a213, v85
    v_mfma_f32_16x16x32_bf16 v[16:19], a[152:155], v[136:139], v[16:19]
    v_accvgpr_write_b32 a214, v86
    v_mfma_f32_16x16x32_bf16 v[16:19], a[148:151], v[116:119], v[16:19]
    ds_read_b64_tr_b16 a[120:121], v46 offset:24576
    v_accvgpr_write_b32 a215, v87
    v_mfma_f32_16x16x32_bf16 v[16:19], a[144:147], v[112:115], v[16:19]
    ds_read_b64_tr_b16 a[122:123], v46 offset:26624
    v_accvgpr_write_b32 a216, v80
    v_mfma_f32_16x16x32_bf16 v[16:19], a[140:143], v[92:95], v[16:19]
    v_accvgpr_write_b32 a217, v81
    v_mfma_f32_16x16x32_bf16 v[16:19], a[136:139], v[88:91], v[16:19]
    ds_read_b64_tr_b16 a[124:125], v46 offset:28672
    v_accvgpr_write_b32 a218, v82
    v_mfma_f32_16x16x32_bf16 v[16:19], a[132:135], a[168:171], v[16:19]
    ds_read_b64_tr_b16 a[126:127], v46 offset:30720
    v_accvgpr_write_b32 a219, v83
    v_mfma_f32_16x16x32_bf16 v[16:19], a[128:131], a[164:167], v[16:19]
    s_waitcnt lgkmcnt(5)
    v_accvgpr_write_b32 a220, v76
    v_mfma_f32_16x16x32_bf16 v[64:67], a[96:99], a[164:167], 0
    ds_read_b64_tr_b16 a[156:157], v47 offset:28672
    v_accvgpr_write_b32 a221, v77
    v_mfma_f32_16x16x32_bf16 v[64:67], a[100:103], a[168:171], v[64:67]
    ds_read_b64_tr_b16 a[158:159], v47 offset:30720
    v_accvgpr_write_b32 a222, v78
    v_mfma_f32_16x16x32_bf16 v[64:67], a[104:107], v[88:91], v[64:67]
    v_accvgpr_write_b32 a223, v79
    v_mfma_f32_16x16x32_bf16 v[64:67], a[108:111], v[92:95], v[64:67]
    ds_read_b64_tr_b16 a[152:153], v47 offset:24576
    v_accvgpr_write_b32 a224, v36
    v_mfma_f32_16x16x32_bf16 v[64:67], a[112:115], v[112:115], v[64:67]
    s_waitcnt lgkmcnt(5)
    ds_read_b64_tr_b16 a[154:155], v47 offset:26624
    v_accvgpr_write_b32 a225, v37
    v_mfma_f32_16x16x32_bf16 v[64:67], a[116:119], v[116:119], v[64:67]
    v_accvgpr_write_b32 a226, v38
    v_mfma_f32_16x16x32_bf16 v[64:67], a[120:123], v[136:139], v[64:67]
    s_waitcnt lgkmcnt(4)
    ds_read_b64_tr_b16 a[148:149], v47 offset:20480
    v_accvgpr_write_b32 a227, v39
    v_mfma_f32_16x16x32_bf16 v[64:67], a[124:127], v[140:143], v[64:67]
    ds_read_b64_tr_b16 a[150:151], v47 offset:22528
    v_accvgpr_write_b32 a228, v32
    v_mfma_f32_16x16x32_bf16 v[68:71], a[124:127], v[148:151], 0
    v_accvgpr_write_b32 a229, v33
    v_mfma_f32_16x16x32_bf16 v[68:71], a[120:123], v[144:147], v[68:71]
    ds_read_b64_tr_b16 a[144:145], v47 offset:16384
    v_accvgpr_write_b32 a230, v34
    v_mfma_f32_16x16x32_bf16 v[68:71], a[116:119], v[124:127], v[68:71]
    ds_read_b64_tr_b16 a[146:147], v47 offset:18432
    v_accvgpr_write_b32 a231, v35
    v_mfma_f32_16x16x32_bf16 v[68:71], a[112:115], v[120:123], v[68:71]
    v_accvgpr_write_b32 a232, v28
    v_mfma_f32_16x16x32_bf16 v[68:71], a[108:111], v[100:103], v[68:71]
    ds_read_b64_tr_b16 a[140:141], v47 offset:12288
    v_accvgpr_write_b32 a233, v29
    v_mfma_f32_16x16x32_bf16 v[68:71], a[104:107], v[96:99], v[68:71]
    ds_read_b64_tr_b16 a[142:143], v47 offset:14336
    v_accvgpr_write_b32 a234, v30
    v_mfma_f32_16x16x32_bf16 v[68:71], a[100:103], a[176:179], v[68:71]
    v_accvgpr_write_b32 a235, v31
    v_mfma_f32_16x16x32_bf16 v[68:71], a[96:99], a[172:175], v[68:71]
    ds_read_b64_tr_b16 a[136:137], v47 offset:8192
    v_mfma_f32_16x16x32_bf16 v[72:75], a[96:99], a[180:183], 0
    ds_read_b64_tr_b16 a[138:139], v47 offset:10240
    v_mfma_f32_16x16x32_bf16 v[72:75], a[100:103], a[184:187], v[72:75]
    v_mfma_f32_16x16x32_bf16 v[72:75], a[104:107], v[104:107], v[72:75]
    ds_read_b64_tr_b16 a[132:133], v47 offset:4096
    v_mfma_f32_16x16x32_bf16 v[72:75], a[108:111], v[108:111], v[72:75]
    ds_read_b64_tr_b16 a[134:135], v47 offset:6144
    v_mfma_f32_16x16x32_bf16 v[72:75], a[112:115], v[128:131], v[72:75]
    v_mfma_f32_16x16x32_bf16 v[72:75], a[116:119], v[132:135], v[72:75]
    ds_read_b64_tr_b16 a[128:129], v47 offset:0
    v_mfma_f32_16x16x32_bf16 v[72:75], a[120:123], v[152:155], v[72:75]
    ds_read_b64_tr_b16 a[130:131], v47 offset:2048
    v_mfma_f32_16x16x32_bf16 v[72:75], a[124:127], v[156:159], v[72:75]
    s_waitcnt vmcnt(8) lgkmcnt(5)
    v_mfma_f32_16x16x32_bf16 v[84:87], a[156:159], v[156:159], 0
    s_barrier
    ds_read_b64_tr_b16 a[96:97], v44 offset:32768
    v_mfma_f32_16x16x32_bf16 v[84:87], a[152:155], v[152:155], v[84:87]
    ds_read_b64_tr_b16 a[98:99], v44 offset:34816
    v_mfma_f32_16x16x32_bf16 v[84:87], a[148:151], v[132:135], v[84:87]
    v_mfma_f32_16x16x32_bf16 v[84:87], a[144:147], v[128:131], v[84:87]
    ds_read_b64_tr_b16 a[100:101], v44 offset:36864
    v_mfma_f32_16x16x32_bf16 v[84:87], a[140:143], v[108:111], v[84:87]
    s_waitcnt lgkmcnt(5)
    ds_read_b64_tr_b16 a[102:103], v44 offset:38912
    v_mfma_f32_16x16x32_bf16 v[84:87], a[136:139], v[104:107], v[84:87]
    v_mfma_f32_16x16x32_bf16 v[84:87], a[132:135], a[184:187], v[84:87]
    s_waitcnt lgkmcnt(4)
    ds_read_b64_tr_b16 a[104:105], v44 offset:40960
    v_mfma_f32_16x16x32_bf16 v[84:87], a[128:131], a[180:183], v[84:87]
    ds_read_b64_tr_b16 a[106:107], v44 offset:43008
    v_mfma_f32_16x16x32_bf16 v[80:83], a[128:131], a[172:175], 0
    v_mfma_f32_16x16x32_bf16 v[80:83], a[132:135], a[176:179], v[80:83]
    ds_read_b64_tr_b16 a[108:109], v44 offset:45056
    v_mfma_f32_16x16x32_bf16 v[80:83], a[136:139], v[96:99], v[80:83]
    ds_read_b64_tr_b16 a[110:111], v44 offset:47104
    v_mfma_f32_16x16x32_bf16 v[80:83], a[140:143], v[100:103], v[80:83]
    v_mfma_f32_16x16x32_bf16 v[80:83], a[144:147], v[120:123], v[80:83]
    ds_read_b64_tr_b16 a[112:113], v44 offset:49152
    v_mfma_f32_16x16x32_bf16 v[80:83], a[148:151], v[124:127], v[80:83]
    ds_read_b64_tr_b16 a[114:115], v44 offset:51200
    v_mfma_f32_16x16x32_bf16 v[80:83], a[152:155], v[144:147], v[80:83]
    v_mfma_f32_16x16x32_bf16 v[80:83], a[156:159], v[148:151], v[80:83]
    ds_read_b64_tr_b16 a[116:117], v44 offset:53248
    v_mfma_f32_16x16x32_bf16 v[76:79], a[156:159], v[140:143], 0
    ds_read_b64_tr_b16 a[118:119], v44 offset:55296
    v_mfma_f32_16x16x32_bf16 v[76:79], a[152:155], v[136:139], v[76:79]
    v_mfma_f32_16x16x32_bf16 v[76:79], a[148:151], v[116:119], v[76:79]
    ds_read_b64_tr_b16 a[120:121], v44 offset:57344
    v_mfma_f32_16x16x32_bf16 v[76:79], a[144:147], v[112:115], v[76:79]
    ds_read_b64_tr_b16 a[122:123], v44 offset:59392
    v_mfma_f32_16x16x32_bf16 v[76:79], a[140:143], v[92:95], v[76:79]
    v_mfma_f32_16x16x32_bf16 v[76:79], a[136:139], v[88:91], v[76:79]
    ds_read_b64_tr_b16 a[124:125], v44 offset:61440
    v_mfma_f32_16x16x32_bf16 v[76:79], a[132:135], a[168:171], v[76:79]
    ds_read_b64_tr_b16 a[126:127], v44 offset:63488
    v_mfma_f32_16x16x32_bf16 v[76:79], a[128:131], a[164:167], v[76:79]
    s_waitcnt lgkmcnt(5)
    v_mfma_f32_16x16x32_bf16 v[4:7], a[96:99], v[160:163], v[4:7]
    ds_read_b64_tr_b16 a[156:157], v45 offset:61440
    v_mfma_f32_16x16x32_bf16 v[4:7], a[100:103], v[164:167], v[4:7]
    ds_read_b64_tr_b16 a[158:159], v45 offset:63488
    v_mfma_f32_16x16x32_bf16 v[4:7], a[104:107], v[184:187], v[4:7]
    v_mfma_f32_16x16x32_bf16 v[4:7], a[108:111], v[188:191], v[4:7]
    ds_read_b64_tr_b16 a[152:153], v45 offset:57344
    v_mfma_f32_16x16x32_bf16 v[4:7], a[112:115], v[208:211], v[4:7]
    s_waitcnt lgkmcnt(5)
    ds_read_b64_tr_b16 a[154:155], v45 offset:59392
    v_mfma_f32_16x16x32_bf16 v[4:7], a[116:119], v[212:215], v[4:7]
    v_mfma_f32_16x16x32_bf16 v[4:7], a[120:123], v[232:235], v[4:7]
    s_waitcnt lgkmcnt(4)
    ds_read_b64_tr_b16 a[148:149], v45 offset:53248
    v_mfma_f32_16x16x32_bf16 v[4:7], a[124:127], v[236:239], v[4:7]
    ds_read_b64_tr_b16 a[150:151], v45 offset:55296
    v_mfma_f32_16x16x32_bf16 v[8:11], a[124:127], v[244:247], v[8:11]
    s_xor_b32 s69, s35, 0
    buffer_store_dwordx4 a[188:191], v63, s[24:27], s69 offen offset:512 nt
    v_mfma_f32_16x16x32_bf16 v[8:11], a[120:123], v[240:243], v[8:11]
    ds_read_b64_tr_b16 a[144:145], v45 offset:49152
    v_mfma_f32_16x16x32_bf16 v[8:11], a[116:119], v[220:223], v[8:11]
    ds_read_b64_tr_b16 a[146:147], v45 offset:51200
    v_mfma_f32_16x16x32_bf16 v[8:11], a[112:115], v[216:219], v[8:11]
    v_mfma_f32_16x16x32_bf16 v[8:11], a[108:111], v[196:199], v[8:11]
    ds_read_b64_tr_b16 a[140:141], v45 offset:45056
    v_mul_f32 v4, v4, v1
    v_mfma_f32_16x16x32_bf16 v[8:11], a[104:107], v[192:195], v[8:11]
    ds_read_b64_tr_b16 a[142:143], v45 offset:47104
    v_mul_f32 v5, v5, v1
    v_mfma_f32_16x16x32_bf16 v[8:11], a[100:103], v[172:175], v[8:11]
    v_mul_f32 v6, v6, v1
    v_mul_f32 v7, v7, v1
    v_mfma_f32_16x16x32_bf16 v[8:11], a[96:99], v[168:171], v[8:11]
    ds_read_b64_tr_b16 a[136:137], v45 offset:40960
    v_mfma_f32_16x16x32_bf16 v[12:15], a[96:99], v[176:179], v[12:15]
    ds_read_b64_tr_b16 a[138:139], v45 offset:43008
    v_mov_b32 v52, s64
    v_mfma_f32_16x16x32_bf16 v[12:15], a[100:103], v[180:183], v[12:15]
    v_mov_b32 v53, s65
    v_mfma_f32_16x16x32_bf16 v[12:15], a[104:107], v[200:203], v[12:15]
    ds_read_b64_tr_b16 a[132:133], v45 offset:36864
    v_mfma_f32_16x16x32_bf16 v[12:15], a[108:111], v[204:207], v[12:15]
    ds_read_b64_tr_b16 a[134:135], v45 offset:38912
    v_mul_f32 v8, v8, v2
    v_mfma_f32_16x16x32_bf16 v[12:15], a[112:115], v[224:227], v[12:15]
    ds_write_b32 v53, v52
    v_mul_f32 v9, v9, v2
    v_mfma_f32_16x16x32_bf16 v[12:15], a[116:119], v[228:231], v[12:15]
    ds_read_b64_tr_b16 a[128:129], v45 offset:32768
    v_mul_f32 v10, v10, v2
    v_mfma_f32_16x16x32_bf16 v[12:15], a[120:123], v[248:251], v[12:15]
    ds_read_b64_tr_b16 a[130:131], v45 offset:34816
    v_mul_f32 v11, v11, v2
    v_mfma_f32_16x16x32_bf16 v[12:15], a[124:127], v[252:255], v[12:15]
    s_waitcnt lgkmcnt(6)
    v_mfma_f32_16x16x32_bf16 v[24:27], a[156:159], v[252:255], v[24:27]
    ds_read_b64_tr_b16 a[96:97], v46 offset:32768
    v_mfma_f32_16x16x32_bf16 v[24:27], a[152:155], v[248:251], v[24:27]
    ds_read_b64_tr_b16 a[98:99], v46 offset:34816
    v_mfma_f32_16x16x32_bf16 v[24:27], a[148:151], v[228:231], v[24:27]
    v_mfma_f32_16x16x32_bf16 v[24:27], a[144:147], v[224:227], v[24:27]
    ds_read_b64_tr_b16 a[100:101], v46 offset:36864
    v_mfma_f32_16x16x32_bf16 v[24:27], a[140:143], v[204:207], v[24:27]
    s_waitcnt lgkmcnt(5)
    ds_read_b64_tr_b16 a[102:103], v46 offset:38912
    v_mul_f32 v12, v12, v3
    v_mfma_f32_16x16x32_bf16 v[24:27], a[136:139], v[200:203], v[24:27]
    v_mul_f32 v13, v13, v3
    v_mul_f32 v14, v14, v3
    v_mfma_f32_16x16x32_bf16 v[24:27], a[132:135], v[180:183], v[24:27]
    s_waitcnt lgkmcnt(4)
    ds_read_b64_tr_b16 a[104:105], v46 offset:40960
    v_mul_f32 v15, v15, v3
    v_mfma_f32_16x16x32_bf16 v[24:27], a[128:131], v[176:179], v[24:27]
    ds_read_b64_tr_b16 a[106:107], v46 offset:43008
    v_mfma_f32_16x16x32_bf16 v[20:23], a[128:131], v[168:171], v[20:23]
    s_xor_b32 s69, s35, 128
    buffer_store_dwordx4 a[212:215], v63, s[24:27], s69 offen offset:512 nt
    v_mfma_f32_16x16x32_bf16 v[20:23], a[132:135], v[172:175], v[20:23]
    ds_read_b64_tr_b16 a[108:109], v46 offset:45056
    v_mfma_f32_16x16x32_bf16 v[20:23], a[136:139], v[192:195], v[20:23]
    ds_read_b64_tr_b16 a[110:111], v46 offset:47104
    v_mfma_f32_16x16x32_bf16 v[20:23], a[140:143], v[196:199], v[20:23]
    v_mfma_f32_16x16x32_bf16 v[20:23], a[144:147], v[216:219], v[20:23]
    ds_read_b64_tr_b16 a[112:113], v46 offset:49152
    v_mul_f32 v24, v24, v3
    v_mfma_f32_16x16x32_bf16 v[20:23], a[148:151], v[220:223], v[20:23]
    ds_read_b64_tr_b16 a[114:115], v46 offset:51200
    v_mul_f32 v25, v25, v3
    v_mfma_f32_16x16x32_bf16 v[20:23], a[152:155], v[240:243], v[20:23]
    v_mul_f32 v26, v26, v3
    v_mul_f32 v27, v27, v3
    v_mfma_f32_16x16x32_bf16 v[20:23], a[156:159], v[244:247], v[20:23]
    ds_read_b64_tr_b16 a[116:117], v46 offset:53248
    v_cvt_pk_bf16_f32 v27, v26, v27
    v_mfma_f32_16x16x32_bf16 v[16:19], a[156:159], v[236:239], v[16:19]
    ds_read_b64_tr_b16 a[118:119], v46 offset:55296
    v_cvt_pk_bf16_f32 v26, v24, v25
    v_mfma_f32_16x16x32_bf16 v[16:19], a[152:155], v[232:235], v[16:19]
    v_cvt_pk_bf16_f32 v24, v12, v13
    v_mfma_f32_16x16x32_bf16 v[16:19], a[148:151], v[212:215], v[16:19]
    ds_read_b64_tr_b16 a[120:121], v46 offset:57344
    v_cvt_pk_bf16_f32 v25, v14, v15
    v_mfma_f32_16x16x32_bf16 v[16:19], a[144:147], v[208:211], v[16:19]
    ds_read_b64_tr_b16 a[122:123], v46 offset:59392
    v_mul_f32 v20, v20, v2
    v_mfma_f32_16x16x32_bf16 v[16:19], a[140:143], v[188:191], v[16:19]
    v_permlane16_swap_b32 v24, v26
    v_mfma_f32_16x16x32_bf16 v[16:19], a[136:139], v[184:187], v[16:19]
    ds_read_b64_tr_b16 a[124:125], v46 offset:61440
    v_mul_f32 v21, v21, v2
    v_mfma_f32_16x16x32_bf16 v[16:19], a[132:135], v[164:167], v[16:19]
    ds_read_b64_tr_b16 a[126:127], v46 offset:63488
    v_mul_f32 v22, v22, v2
    v_mfma_f32_16x16x32_bf16 v[16:19], a[128:131], v[160:163], v[16:19]
    s_waitcnt lgkmcnt(5)
    v_permlane16_swap_b32 v25, v27
    v_mfma_f32_16x16x32_bf16 v[64:67], a[96:99], v[160:163], v[64:67]
    ds_read_b64_tr_b16 a[156:157], v47 offset:61440
    v_mul_f32 v23, v23, v2
    v_mfma_f32_16x16x32_bf16 v[64:67], a[100:103], v[164:167], v[64:67]
    ds_read_b64_tr_b16 a[158:159], v47 offset:63488
    v_cvt_pk_bf16_f32 v23, v22, v23
    v_mfma_f32_16x16x32_bf16 v[64:67], a[104:107], v[184:187], v[64:67]
    v_cvt_pk_bf16_f32 v22, v20, v21
    v_mfma_f32_16x16x32_bf16 v[64:67], a[108:111], v[188:191], v[64:67]
    ds_read_b64_tr_b16 a[152:153], v47 offset:57344
    v_cvt_pk_bf16_f32 v20, v8, v9
    v_mfma_f32_16x16x32_bf16 v[64:67], a[112:115], v[208:211], v[64:67]
    s_waitcnt lgkmcnt(5)
    ds_read_b64_tr_b16 a[154:155], v47 offset:59392
    v_cvt_pk_bf16_f32 v21, v10, v11
    v_mfma_f32_16x16x32_bf16 v[64:67], a[116:119], v[212:215], v[64:67]
    s_xor_b32 s69, s33, 0
    buffer_store_dwordx4 a[192:195], v63, s[24:27], s69 offen offset:512 nt
    v_mfma_f32_16x16x32_bf16 v[64:67], a[120:123], v[232:235], v[64:67]
    s_waitcnt lgkmcnt(4)
    ds_read_b64_tr_b16 a[148:149], v47 offset:53248
    v_mul_f32 v16, v16, v1
    v_mfma_f32_16x16x32_bf16 v[64:67], a[124:127], v[236:239], v[64:67]
    ds_read_b64_tr_b16 a[150:151], v47 offset:55296
    v_mul_f32 v17, v17, v1
    v_mfma_f32_16x16x32_bf16 v[68:71], a[124:127], v[244:247], v[68:71]
    v_permlane16_swap_b32 v20, v22
    v_mfma_f32_16x16x32_bf16 v[68:71], a[120:123], v[240:243], v[68:71]
    ds_read_b64_tr_b16 a[144:145], v47 offset:49152
    v_mul_f32 v18, v18, v1
    v_mfma_f32_16x16x32_bf16 v[68:71], a[116:119], v[220:223], v[68:71]
    ds_read_b64_tr_b16 a[146:147], v47 offset:51200
    v_mul_f32 v19, v19, v1
    v_mfma_f32_16x16x32_bf16 v[68:71], a[112:115], v[216:219], v[68:71]
    v_permlane16_swap_b32 v21, v23
    v_mfma_f32_16x16x32_bf16 v[68:71], a[108:111], v[196:199], v[68:71]
    ds_read_b64_tr_b16 a[140:141], v47 offset:45056
    v_cvt_pk_bf16_f32 v19, v18, v19
    v_mfma_f32_16x16x32_bf16 v[68:71], a[104:107], v[192:195], v[68:71]
    ds_read_b64_tr_b16 a[142:143], v47 offset:47104
    v_cvt_pk_bf16_f32 v18, v16, v17
    v_mfma_f32_16x16x32_bf16 v[68:71], a[100:103], v[172:175], v[68:71]
    v_cvt_pk_bf16_f32 v16, v4, v5
    v_mfma_f32_16x16x32_bf16 v[68:71], a[96:99], v[168:171], v[68:71]
    ds_read_b64_tr_b16 a[136:137], v47 offset:40960
    v_cvt_pk_bf16_f32 v17, v6, v7
    v_mfma_f32_16x16x32_bf16 v[72:75], a[96:99], v[176:179], v[72:75]
    ds_read_b64_tr_b16 a[138:139], v47 offset:43008
    v_mul_f32 v64, v64, v1
    v_mfma_f32_16x16x32_bf16 v[72:75], a[100:103], v[180:183], v[72:75]
    v_permlane16_swap_b32 v16, v18
    v_mfma_f32_16x16x32_bf16 v[72:75], a[104:107], v[200:203], v[72:75]
    ds_read_b64_tr_b16 a[132:133], v47 offset:36864
    v_mul_f32 v65, v65, v1
    v_mfma_f32_16x16x32_bf16 v[72:75], a[108:111], v[204:207], v[72:75]
    ds_read_b64_tr_b16 a[134:135], v47 offset:38912
    v_mul_f32 v66, v66, v1
    v_mfma_f32_16x16x32_bf16 v[72:75], a[112:115], v[224:227], v[72:75]
    s_xor_b32 s69, s33, 128
    buffer_store_dwordx4 a[216:219], v63, s[24:27], s69 offen offset:512 nt
    v_mfma_f32_16x16x32_bf16 v[72:75], a[116:119], v[228:231], v[72:75]
    ds_read_b64_tr_b16 a[128:129], v47 offset:32768
    v_mul_f32 v67, v67, v1
    v_mfma_f32_16x16x32_bf16 v[72:75], a[120:123], v[248:251], v[72:75]
    ds_read_b64_tr_b16 a[130:131], v47 offset:34816
    v_cvt_pk_bf16_f32 v64, v64, v65
    v_mfma_f32_16x16x32_bf16 v[72:75], a[124:127], v[252:255], v[72:75]
    s_waitcnt lgkmcnt(5)
    v_permlane16_swap_b32 v17, v19
    v_mfma_f32_16x16x32_bf16 v[84:87], a[156:159], v[252:255], v[84:87]
    ds_read_b64_tr_b16 a[96:97], v48 offset:0
    v_cvt_pk_bf16_f32 v65, v66, v67
    v_mfma_f32_16x16x32_bf16 v[84:87], a[152:155], v[248:251], v[84:87]
    ds_read_b64_tr_b16 a[98:99], v48 offset:2048
    v_mul_f32 v68, v68, v2
    v_mfma_f32_16x16x32_bf16 v[84:87], a[148:151], v[228:231], v[84:87]
    v_mul_f32 v69, v69, v2
    v_mul_f32 v70, v70, v2
    v_mfma_f32_16x16x32_bf16 v[84:87], a[144:147], v[224:227], v[84:87]
    ds_read_b64_tr_b16 a[100:101], v48 offset:4096
    v_mul_f32 v71, v71, v2
    v_mfma_f32_16x16x32_bf16 v[84:87], a[140:143], v[204:207], v[84:87]
    s_waitcnt lgkmcnt(5)
    ds_read_b64_tr_b16 a[102:103], v48 offset:6144
    v_cvt_pk_bf16_f32 v68, v68, v69
    v_mfma_f32_16x16x32_bf16 v[84:87], a[136:139], v[200:203], v[84:87]
    v_cvt_pk_bf16_f32 v69, v70, v71
    v_mul_f32 v72, v72, v3
    v_mfma_f32_16x16x32_bf16 v[84:87], a[132:135], v[180:183], v[84:87]
    s_waitcnt lgkmcnt(4)
    ds_read_b64_tr_b16 a[104:105], v48 offset:8192
    v_mul_f32 v73, v73, v3
    v_mfma_f32_16x16x32_bf16 v[84:87], a[128:131], v[176:179], v[84:87]
    ds_read_b64_tr_b16 a[106:107], v48 offset:10240
    v_mul_f32 v74, v74, v3
    v_mfma_f32_16x16x32_bf16 v[80:83], a[128:131], v[168:171], v[80:83]
    s_xor_b32 s69, s31, 0
    buffer_store_dwordx4 a[196:199], v63, s[24:27], s69 offen offset:512 nt
    v_mfma_f32_16x16x32_bf16 v[80:83], a[132:135], v[172:175], v[80:83]
    ds_read_b64_tr_b16 a[108:109], v48 offset:12288
    v_mul_f32 v75, v75, v3
    v_mfma_f32_16x16x32_bf16 v[80:83], a[136:139], v[192:195], v[80:83]
    ds_read_b64_tr_b16 a[110:111], v48 offset:14336
    v_cvt_pk_bf16_f32 v72, v72, v73
    v_mfma_f32_16x16x32_bf16 v[80:83], a[140:143], v[196:199], v[80:83]
    v_cvt_pk_bf16_f32 v73, v74, v75
    v_mul_f32 v84, v84, v3
    v_mfma_f32_16x16x32_bf16 v[80:83], a[144:147], v[216:219], v[80:83]
    ds_read_b64_tr_b16 a[112:113], v48 offset:16384
    v_mul_f32 v85, v85, v3
    v_mfma_f32_16x16x32_bf16 v[80:83], a[148:151], v[220:223], v[80:83]
    ds_read_b64_tr_b16 a[114:115], v48 offset:18432
    v_mul_f32 v86, v86, v3
    v_mfma_f32_16x16x32_bf16 v[80:83], a[152:155], v[240:243], v[80:83]
    v_mul_f32 v87, v87, v3
    v_cvt_pk_bf16_f32 v74, v84, v85
    v_mfma_f32_16x16x32_bf16 v[80:83], a[156:159], v[244:247], v[80:83]
    ds_read_b64_tr_b16 a[116:117], v48 offset:20480
    v_cvt_pk_bf16_f32 v75, v86, v87
    v_mfma_f32_16x16x32_bf16 v[76:79], a[156:159], v[236:239], v[76:79]
    ds_read_b64_tr_b16 a[118:119], v48 offset:22528
    v_mfma_f32_16x16x32_bf16 v[76:79], a[152:155], v[232:235], v[76:79]
L_pad6:
    s_cbranch_execz L_back
    v_permlane16_swap_b32 v72, v74
    v_mfma_f32_16x16x32_bf16 v[76:79], a[148:151], v[212:215], v[76:79]
    ds_read_b64_tr_b16 a[120:121], v48 offset:24576
    v_mfma_f32_16x16x32_bf16 v[76:79], a[144:147], v[208:211], v[76:79]
    ds_read_b64_tr_b16 a[122:123], v48 offset:26624
    v_mul_f32 v80, v80, v2
    v_mfma_f32_16x16x32_bf16 v[76:79], a[140:143], v[188:191], v[76:79]
    s_xor_b32 s69, s31, 128
    buffer_store_dwordx4 a[220:223], v63, s[24:27], s69 offen offset:512 nt
    v_mfma_f32_16x16x32_bf16 v[76:79], a[136:139], v[184:187], v[76:79]
    ds_read_b64_tr_b16 a[124:125], v48 offset:28672
    v_mul_f32 v81, v81, v2
    v_mfma_f32_16x16x32_bf16 v[76:79], a[132:135], v[164:167], v[76:79]
    ds_read_b64_tr_b16 a[126:127], v48 offset:30720
    v_mul_f32 v82, v82, v2
    v_mfma_f32_16x16x32_bf16 v[76:79], a[128:131], v[160:163], v[76:79]
    s_waitcnt lgkmcnt(5)
    v_permlane16_swap_b32 v73, v75
    v_mfma_f32_16x16x32_bf16 v[28:31], a[96:99], a[164:167], 0
    ds_read_b64_tr_b16 a[156:157], v49 offset:28672
    v_mul_f32 v83, v83, v2
    v_mfma_f32_16x16x32_bf16 v[28:31], a[100:103], a[168:171], v[28:31]
    s_mov_b64 vcc, s[70:71]
    ds_read_b64_tr_b16 a[158:159], v49 offset:30720
    v_cvt_pk_bf16_f32 v70, v80, v81
    v_mfma_f32_16x16x32_bf16 v[28:31], a[104:107], v[88:91], v[28:31]
    v_cvt_pk_bf16_f32 v71, v82, v83
    v_mul_f32 v76, v76, v1
    v_mfma_f32_16x16x32_bf16 v[28:31], a[108:111], v[92:95], v[28:31]
    ds_read_b64_tr_b16 a[152:153], v49 offset:24576
    v_mul_f32 v77, v77, v1
    v_mfma_f32_16x16x32_bf16 v[28:31], a[112:115], v[112:115], v[28:31]
    s_waitcnt lgkmcnt(5)
    ds_read_b64_tr_b16 a[154:155], v49 offset:26624
    v_mul_f32 v78, v78, v1
    v_mfma_f32_16x16x32_bf16 v[28:31], a[116:119], v[116:119], v[28:31]
    s_xor_b32 s69, s35, 0
    buffer_store_dwordx4 a[200:203], v63, s[24:27], s69 offen offset:0 nt
    v_mfma_f32_16x16x32_bf16 v[28:31], a[120:123], v[136:139], v[28:31]
    s_waitcnt lgkmcnt(4)
    ds_read_b64_tr_b16 a[148:149], v49 offset:20480
    v_mul_f32 v79, v79, v1
    v_mfma_f32_16x16x32_bf16 v[28:31], a[124:127], v[140:143], v[28:31]
    ds_read_b64_tr_b16 a[150:151], v49 offset:22528
    v_cvt_pk_bf16_f32 v66, v76, v77
    v_mfma_f32_16x16x32_bf16 v[32:35], a[124:127], v[148:151], 0
    v_permlane16_swap_b32 v68, v70
    v_mfma_f32_16x16x32_bf16 v[32:35], a[120:123], v[144:147], v[32:35]
    ds_read_b64_tr_b16 a[144:145], v49 offset:16384
    v_cvt_pk_bf16_f32 v67, v78, v79
    v_mfma_f32_16x16x32_bf16 v[32:35], a[116:119], v[124:127], v[32:35]
    ds_read_b64_tr_b16 a[146:147], v49 offset:18432
    v_cndmask_b32_dpp v84, v72, v24, vcc quad_perm:[1,0,3,2] row_mask:0xf bank_mask:0xf
    v_mfma_f32_16x16x32_bf16 v[32:35], a[112:115], v[120:123], v[32:35]
    v_permlane16_swap_b32 v69, v71
    v_mfma_f32_16x16x32_bf16 v[32:35], a[108:111], v[100:103], v[32:35]
    ds_read_b64_tr_b16 a[140:141], v49 offset:12288
    v_cndmask_b32_dpp v85, v73, v25, vcc quad_perm:[1,0,3,2] row_mask:0xf bank_mask:0xf
    v_mfma_f32_16x16x32_bf16 v[32:35], a[104:107], v[96:99], v[32:35]
    ds_read_b64_tr_b16 a[142:143], v49 offset:14336
    v_cndmask_b32_dpp v86, v74, v26, vcc quad_perm:[1,0,3,2] row_mask:0xf bank_mask:0xf
    v_mfma_f32_16x16x32_bf16 v[32:35], a[100:103], a[176:179], v[32:35]
    v_permlane16_swap_b32 v64, v66
    v_mfma_f32_16x16x32_bf16 v[32:35], a[96:99], a[172:175], v[32:35]
    ds_read_b64_tr_b16 a[136:137], v49 offset:8192
    v_cndmask_b32_dpp v87, v75, v27, vcc quad_perm:[1,0,3,2] row_mask:0xf bank_mask:0xf
    v_mfma_f32_16x16x32_bf16 v[36:39], a[96:99], a[180:183], 0
    s_not_b64 vcc, s[70:71]
    ds_read_b64_tr_b16 a[138:139], v49 offset:10240
    v_cndmask_b32_dpp v72, v24, v72, vcc quad_perm:[1,0,3,2] row_mask:0xf bank_mask:0xf
    v_mfma_f32_16x16x32_bf16 v[36:39], a[100:103], a[184:187], v[36:39]
    s_xor_b32 s69, s35, 256
    buffer_store_dwordx4 v[84:87], v63, s[24:27], s69 offen offset:0 nt
    v_mfma_f32_16x16x32_bf16 v[36:39], a[104:107], v[104:107], v[36:39]
    ds_read_b64_tr_b16 a[132:133], v49 offset:4096
    v_cndmask_b32_dpp v73, v25, v73, vcc quad_perm:[1,0,3,2] row_mask:0xf bank_mask:0xf
    v_mfma_f32_16x16x32_bf16 v[36:39], a[108:111], v[108:111], v[36:39]
    ds_read_b64_tr_b16 a[134:135], v49 offset:6144
    v_cndmask_b32_dpp v74, v26, v74, vcc quad_perm:[1,0,3,2] row_mask:0xf bank_mask:0xf
    v_mfma_f32_16x16x32_bf16 v[36:39], a[112:115], v[128:131], v[36:39]
    v_permlane16_swap_b32 v65, v67
    v_mfma_f32_16x16x32_bf16 v[36:39], a[116:119], v[132:135], v[36:39]
    ds_read_b64_tr_b16 a[128:129], v49 offset:0
    v_cndmask_b32_dpp v75, v27, v75, vcc quad_perm:[1,0,3,2] row_mask:0xf bank_mask:0xf
    v_mfma_f32_16x16x32_bf16 v[36:39], a[120:123], v[152:155], v[36:39]
    s_mov_b64 vcc, s[70:71]
    ds_read_b64_tr_b16 a[130:131], v49 offset:2048
    v_cndmask_b32_dpp v80, v68, v20, vcc quad_perm:[1,0,3,2] row_mask:0xf bank_mask:0xf
    v_mfma_f32_16x16x32_bf16 v[36:39], a[124:127], v[156:159], v[36:39]
    s_waitcnt lgkmcnt(5)
    v_cndmask_b32_dpp v81, v69, v21, vcc quad_perm:[1,0,3,2] row_mask:0xf bank_mask:0xf
    v_mfma_f32_16x16x32_bf16 v[12:15], a[156:159], v[156:159], 0
    ds_read_b64_tr_b16 a[96:97], v50 offset:0
    v_cndmask_b32_dpp v82, v70, v22, vcc quad_perm:[1,0,3,2] row_mask:0xf bank_mask:0xf
    v_mfma_f32_16x16x32_bf16 v[12:15], a[152:155], v[152:155], v[12:15]
    ds_read_b64_tr_b16 a[98:99], v50 offset:2048
    v_cndmask_b32_dpp v83, v71, v23, vcc quad_perm:[1,0,3,2] row_mask:0xf bank_mask:0xf
    v_mfma_f32_16x16x32_bf16 v[12:15], a[148:151], v[132:135], v[12:15]
    s_not_b64 vcc, s[70:71]
    v_cndmask_b32_dpp v68, v20, v68, vcc quad_perm:[1,0,3,2] row_mask:0xf bank_mask:0xf
    v_mfma_f32_16x16x32_bf16 v[12:15], a[144:147], v[128:131], v[12:15]
    ds_read_b64_tr_b16 a[100:101], v50 offset:4096
    v_cndmask_b32_dpp v69, v21, v69, vcc quad_perm:[1,0,3,2] row_mask:0xf bank_mask:0xf
    v_mfma_f32_16x16x32_bf16 v[12:15], a[140:143], v[108:111], v[12:15]
    s_waitcnt lgkmcnt(5)
    ds_read_b64_tr_b16 a[102:103], v50 offset:6144
    v_cndmask_b32_dpp v70, v22, v70, vcc quad_perm:[1,0,3,2] row_mask:0xf bank_mask:0xf
    v_mfma_f32_16x16x32_bf16 v[12:15], a[136:139], v[104:107], v[12:15]
    s_xor_b32 s69, s35, 256
    buffer_store_dwordx4 v[72:75], v63, s[24:27], s69 offen offset:512 nt
    v_mfma_f32_16x16x32_bf16 v[12:15], a[132:135], a[184:187], v[12:15]
    s_waitcnt lgkmcnt(4)
    ds_read_b64_tr_b16 a[104:105], v50 offset:8192
    v_cndmask_b32_dpp v71, v23, v71, vcc quad_perm:[1,0,3,2] row_mask:0xf bank_mask:0xf
    v_mfma_f32_16x16x32_bf16 v[12:15], a[128:131], a[180:183], v[12:15]
    s_mov_b64 vcc, s[70:71]
    ds_read_b64_tr_b16 a[106:107], v50 offset:10240
    v_cndmask_b32_dpp v76, v64, v16, vcc quad_perm:[1,0,3,2] row_mask:0xf bank_mask:0xf
    v_mfma_f32_16x16x32_bf16 v[8:11], a[128:131], a[172:175], 0
    v_cndmask_b32_dpp v77, v65, v17, vcc quad_perm:[1,0,3,2] row_mask:0xf bank_mask:0xf
    v_mfma_f32_16x16x32_bf16 v[8:11], a[132:135], a[176:179], v[8:11]
    s_waitcnt vmcnt(9) lgkmcnt(15)
    ds_read_b64_tr_b16 a[108:109], v50 offset:12288
    v_cndmask_b32_dpp v78, v66, v18, vcc quad_perm:[1,0,3,2] row_mask:0xf bank_mask:0xf
    v_mfma_f32_16x16x32_bf16 v[8:11], a[136:139], v[96:99], v[8:11]
    s_barrier
    ds_read_b64_tr_b16 a[110:111], v50 offset:14336
    v_cndmask_b32_dpp v79, v67, v19, vcc quad_perm:[1,0,3,2] row_mask:0xf bank_mask:0xf
    v_mfma_f32_16x16x32_bf16 v[8:11], a[140:143], v[100:103], v[8:11]
    s_not_b64 vcc, s[70:71]
    ds_read_b64_tr_b16 a[28:29], v41 offset:28672
    v_cndmask_b32_dpp v64, v16, v64, vcc quad_perm:[1,0,3,2] row_mask:0xf bank_mask:0xf
    v_mfma_f32_16x16x32_bf16 v[8:11], a[144:147], v[120:123], v[8:11]
    ds_read_b64_tr_b16 a[112:113], v50 offset:16384
    v_cndmask_b32_dpp v65, v17, v65, vcc quad_perm:[1,0,3,2] row_mask:0xf bank_mask:0xf
    v_mfma_f32_16x16x32_bf16 v[8:11], a[148:151], v[124:127], v[8:11]
    ds_read_b64_tr_b16 a[114:115], v50 offset:18432
    v_cndmask_b32_dpp v66, v18, v66, vcc quad_perm:[1,0,3,2] row_mask:0xf bank_mask:0xf
    v_mfma_f32_16x16x32_bf16 v[8:11], a[152:155], v[144:147], v[8:11]
    s_xor_b32 s69, s33, 256
    buffer_store_dwordx4 v[68:71], v63, s[24:27], s69 offen offset:512 nt
    v_mfma_f32_16x16x32_bf16 v[8:11], a[156:159], v[148:151], v[8:11]
    ds_read_b64_tr_b16 a[116:117], v50 offset:20480
    v_cndmask_b32_dpp v67, v19, v67, vcc quad_perm:[1,0,3,2] row_mask:0xf bank_mask:0xf
    v_mfma_f32_16x16x32_bf16 v[4:7], a[156:159], v[140:143], 0
    ds_read_b64_tr_b16 a[118:119], v50 offset:22528
    v_mov_b32 v54, 48128
    v_mfma_f32_16x16x32_bf16 v[4:7], a[152:155], v[136:139], v[4:7]
    ds_read_b64_tr_b16 a[30:31], v41 offset:30720
    v_mfma_f32_16x16x32_bf16 v[4:7], a[148:151], v[116:119], v[4:7]
    ds_read_b64_tr_b16 a[120:121], v50 offset:24576
    v_mfma_f32_16x16x32_bf16 v[4:7], a[144:147], v[112:115], v[4:7]
    ds_read_b64_tr_b16 a[122:123], v50 offset:26624
    v_mfma_f32_16x16x32_bf16 v[4:7], a[140:143], v[92:95], v[4:7]
    ds_read_b64_tr_b16 a[24:25], v41 offset:24576
    v_mfma_f32_16x16x32_bf16 v[4:7], a[136:139], v[88:91], v[4:7]
    ds_read_b64_tr_b16 a[124:125], v50 offset:28672
    v_mfma_f32_16x16x32_bf16 v[4:7], a[132:135], a[168:171], v[4:7]
    ds_read_b64_tr_b16 a[126:127], v50 offset:30720
    v_mfma_f32_16x16x32_bf16 v[4:7], a[128:131], a[164:167], v[4:7]
    s_waitcnt lgkmcnt(7)
    ds_read_b64_tr_b16 a[26:27], v41 offset:26624
    v_mfma_f32_16x16x32_bf16 v[16:19], a[96:99], a[164:167], 0
    ds_read_b64_tr_b16 a[156:157], v51 offset:28672
    v_mfma_f32_16x16x32_bf16 v[16:19], a[100:103], a[168:171], v[16:19]
    ds_read_b64_tr_b16 a[158:159], v51 offset:30720
    v_mfma_f32_16x16x32_bf16 v[16:19], a[104:107], v[88:91], v[16:19]
    s_xor_b32 s69, s31, 256
    buffer_store_dwordx4 v[64:67], v63, s[24:27], s69 offen offset:512 nt
    v_mfma_f32_16x16x32_bf16 v[16:19], a[108:111], v[92:95], v[16:19]
    ds_read_b64_tr_b16 a[152:153], v51 offset:24576
    v_mfma_f32_16x16x32_bf16 v[16:19], a[112:115], v[112:115], v[16:19]
    s_waitcnt lgkmcnt(6)
    ds_read_b64_tr_b16 a[154:155], v51 offset:26624
    v_mfma_f32_16x16x32_bf16 v[16:19], a[116:119], v[116:119], v[16:19]
    ds_read_b64_tr_b16 a[20:21], v41 offset:20480
    v_mfma_f32_16x16x32_bf16 v[16:19], a[120:123], v[136:139], v[16:19]
    s_waitcnt lgkmcnt(6)
    ds_read_b64_tr_b16 a[148:149], v51 offset:20480
    v_mfma_f32_16x16x32_bf16 v[16:19], a[124:127], v[140:143], v[16:19]
    ds_read_b64_tr_b16 a[150:151], v51 offset:22528
    v_mfma_f32_16x16x32_bf16 v[20:23], a[124:127], v[148:151], 0
    ds_read_b64_tr_b16 a[22:23], v41 offset:22528
    v_mfma_f32_16x16x32_bf16 v[20:23], a[120:123], v[144:147], v[20:23]
    ds_read_b64_tr_b16 a[144:145], v51 offset:16384
    v_mfma_f32_16x16x32_bf16 v[20:23], a[116:119], v[124:127], v[20:23]
    ds_read_b64_tr_b16 a[146:147], v51 offset:18432
    v_mfma_f32_16x16x32_bf16 v[20:23], a[112:115], v[120:123], v[20:23]
    ds_read_b64_tr_b16 a[16:17], v41 offset:16384
    v_mfma_f32_16x16x32_bf16 v[20:23], a[108:111], v[100:103], v[20:23]
    ds_read_b64_tr_b16 a[140:141], v51 offset:12288
    v_mfma_f32_16x16x32_bf16 v[20:23], a[104:107], v[96:99], v[20:23]
    ds_read_b64_tr_b16 a[142:143], v51 offset:14336
    v_mfma_f32_16x16x32_bf16 v[20:23], a[100:103], a[176:179], v[20:23]
    s_xor_b32 s69, s33, 256
    buffer_store_dwordx4 v[80:83], v63, s[24:27], s69 offen offset:0 nt
    v_mfma_f32_16x16x32_bf16 v[20:23], a[96:99], a[172:175], v[20:23]
    ds_read_b64_tr_b16 a[136:137], v51 offset:8192
    v_mfma_f32_16x16x32_bf16 v[24:27], a[96:99], a[180:183], 0
    ds_read_b64_tr_b16 a[138:139], v51 offset:10240
    v_mfma_f32_16x16x32_bf16 v[24:27], a[100:103], a[184:187], v[24:27]
    ds_read_b64_tr_b16 a[18:19], v41 offset:18432
    v_mfma_f32_16x16x32_bf16 v[24:27], a[104:107], v[104:107], v[24:27]
    ds_read_b64_tr_b16 a[132:133], v51 offset:4096
    v_mfma_f32_16x16x32_bf16 v[24:27], a[108:111], v[108:111], v[24:27]
    ds_read_b64_tr_b16 a[134:135], v51 offset:6144
    v_mfma_f32_16x16x32_bf16 v[24:27], a[112:115], v[128:131], v[24:27]
    ds_read_b64_tr_b16 a[12:13], v41 offset:12288
    v_mfma_f32_16x16x32_bf16 v[24:27], a[116:119], v[132:135], v[24:27]
    ds_read_b64_tr_b16 a[128:129], v51 offset:0
    v_mfma_f32_16x16x32_bf16 v[24:27], a[120:123], v[152:155], v[24:27]
    s_waitcnt lgkmcnt(7)
    ds_read_b64_tr_b16 a[130:131], v51 offset:2048
    v_mfma_f32_16x16x32_bf16 v[24:27], a[124:127], v[156:159], v[24:27]
    s_xor_b32 s69, s31, 256
    buffer_store_dwordx4 v[76:79], v63, s[24:27], s69 offen offset:0 nt
    v_mfma_f32_16x16x32_bf16 v[72:75], a[156:159], v[156:159], 0
    ds_read_b64_tr_b16 a[96:97], v40 offset:0
    v_mfma_f32_16x16x32_bf16 v[72:75], a[152:155], v[152:155], v[72:75]
    ds_read_b64_tr_b16 a[98:99], v40 offset:2048
    v_mfma_f32_16x16x32_bf16 v[72:75], a[148:151], v[132:135], v[72:75]
    ds_read_b64_tr_b16 a[14:15], v41 offset:14336
    v_mfma_f32_16x16x32_bf16 v[72:75], a[144:147], v[128:131], v[72:75]
    ds_read_b64_tr_b16 a[100:101], v40 offset:4096
    v_mfma_f32_16x16x32_bf16 v[72:75], a[140:143], v[108:111], v[72:75]
    s_waitcnt lgkmcnt(6)
    ds_read_b64_tr_b16 a[102:103], v40 offset:6144
    v_mfma_f32_16x16x32_bf16 v[72:75], a[136:139], v[104:107], v[72:75]
    ds_read_b64_tr_b16 a[8:9], v41 offset:8192
    v_mfma_f32_16x16x32_bf16 v[72:75], a[132:135], a[184:187], v[72:75]
    s_waitcnt lgkmcnt(6)
    ds_read_b64_tr_b16 a[104:105], v40 offset:8192
    v_mfma_f32_16x16x32_bf16 v[72:75], a[128:131], a[180:183], v[72:75]
    ds_read_b64_tr_b16 a[106:107], v40 offset:10240
    v_mfma_f32_16x16x32_bf16 v[68:71], a[128:131], a[172:175], 0
    ds_read_b64_tr_b16 a[10:11], v41 offset:10240
    v_mfma_f32_16x16x32_bf16 v[68:71], a[132:135], a[176:179], v[68:71]
    ds_read_b64_tr_b16 a[108:109], v40 offset:12288
    v_mfma_f32_16x16x32_bf16 v[68:71], a[136:139], v[96:99], v[68:71]
    ds_read_b64_tr_b16 a[110:111], v40 offset:14336
    v_mfma_f32_16x16x32_bf16 v[68:71], a[140:143], v[100:103], v[68:71]
    s_xor_b32 s69, s35, 128
    buffer_store_dwordx4 a[224:227], v63, s[24:27], s69 offen offset:0 nt
    v_mfma_f32_16x16x32_bf16 v[68:71], a[144:147], v[120:123], v[68:71]
    ds_read_b64_tr_b16 a[112:113], v40 offset:16384
    v_mfma_f32_16x16x32_bf16 v[68:71], a[148:151], v[124:127], v[68:71]
    ds_read_b64_tr_b16 a[114:115], v40 offset:18432
    v_mfma_f32_16x16x32_bf16 v[68:71], a[152:155], v[144:147], v[68:71]
    ds_read_b64_tr_b16 a[4:5], v41 offset:4096
    v_mfma_f32_16x16x32_bf16 v[68:71], a[156:159], v[148:151], v[68:71]
    ds_read_b64_tr_b16 a[116:117], v40 offset:20480
    v_mfma_f32_16x16x32_bf16 v[64:67], a[156:159], v[140:143], 0
    ds_read_b64_tr_b16 a[118:119], v40 offset:22528
    v_mfma_f32_16x16x32_bf16 v[64:67], a[152:155], v[136:139], v[64:67]
    ds_read_b64_tr_b16 a[6:7], v41 offset:6144
    v_mfma_f32_16x16x32_bf16 v[64:67], a[148:151], v[116:119], v[64:67]
    ds_read_b64_tr_b16 a[120:121], v40 offset:24576
    v_mfma_f32_16x16x32_bf16 v[64:67], a[144:147], v[112:115], v[64:67]
    ds_read_b64_tr_b16 a[122:123], v40 offset:26624
    v_mfma_f32_16x16x32_bf16 v[64:67], a[140:143], v[92:95], v[64:67]
    ds_read_b64_tr_b16 a[0:1], v41 offset:0
    v_mfma_f32_16x16x32_bf16 v[64:67], a[136:139], v[88:91], v[64:67]
    ds_read_b64_tr_b16 a[124:125], v40 offset:28672
    v_mfma_f32_16x16x32_bf16 v[64:67], a[132:135], a[168:171], v[64:67]
    s_waitcnt lgkmcnt(7)
    ds_read_b64_tr_b16 a[126:127], v40 offset:30720
    v_mfma_f32_16x16x32_bf16 v[64:67], a[128:131], a[164:167], v[64:67]
    s_xor_b32 s69, s33, 0
    buffer_store_dwordx4 a[204:207], v63, s[24:27], s69 offen offset:0 nt
    v_mfma_f32_16x16x32_bf16 v[28:31], a[96:99], v[160:163], v[28:31]
    ds_read_b64_tr_b16 a[2:3], v41 offset:2048
    ds_read_b64_tr_b16 a[32:33], v42 offset:0
    v_mfma_f32_16x16x32_bf16 v[28:31], a[100:103], v[164:167], v[28:31]
    ds_read_b64_tr_b16 a[34:35], v42 offset:2048
    v_mfma_f32_16x16x32_bf16 v[28:31], a[104:107], v[184:187], v[28:31]
    ds_read_b64_tr_b16 a[36:37], v42 offset:4096
    ds_read_b64_tr_b16 a[38:39], v42 offset:6144
    v_mfma_f32_16x16x32_bf16 v[28:31], a[108:111], v[188:191], v[28:31]
    ds_read_b64_tr_b16 a[40:41], v42 offset:8192
    v_mfma_f32_16x16x32_bf16 v[28:31], a[112:115], v[208:211], v[28:31]
    s_waitcnt lgkmcnt(8)
    ds_read_b64_tr_b16 a[42:43], v42 offset:10240
    ds_read_b64_tr_b16 a[44:45], v42 offset:12288
    v_mfma_f32_16x16x32_bf16 v[28:31], a[116:119], v[212:215], v[28:31]
    ds_read_b64_tr_b16 a[46:47], v42 offset:14336
    v_mfma_f32_16x16x32_bf16 v[28:31], a[120:123], v[232:235], v[28:31]
    s_waitcnt lgkmcnt(9)
    ds_read_b64_tr_b16 a[48:49], v42 offset:16384
    ds_read_b64_tr_b16 a[50:51], v42 offset:18432
    v_mfma_f32_16x16x32_bf16 v[28:31], a[124:127], v[236:239], v[28:31]
    ds_read_b64_tr_b16 a[52:53], v42 offset:20480
    v_mfma_f32_16x16x32_bf16 v[4:7], a[28:31], v[236:239], v[4:7]
    s_xor_b32 s69, s33, 128
    buffer_store_dwordx4 a[228:231], v63, s[24:27], s69 offen offset:0 nt
    v_mfma_f32_16x16x32_bf16 v[4:7], a[24:27], v[232:235], v[4:7]
    ds_read_b64_tr_b16 a[54:55], v42 offset:22528
    v_mfma_f32_16x16x32_bf16 v[4:7], a[20:23], v[212:215], v[4:7]
    ds_read_b64_tr_b16 a[56:57], v42 offset:24576
    ds_read_b64_tr_b16 a[58:59], v42 offset:26624
    v_mfma_f32_16x16x32_bf16 v[4:7], a[16:19], v[208:211], v[4:7]
    ds_read_b64_tr_b16 a[60:61], v42 offset:28672
    v_mul_f32 v28, v28, v1
    v_mfma_f32_16x16x32_bf16 v[4:7], a[12:15], v[188:191], v[4:7]
    ds_read_b64_tr_b16 a[62:63], v42 offset:30720
    ds_read_b64_tr_b16 a[92:93], v43 offset:28672
    v_mfma_f32_16x16x32_bf16 v[4:7], a[8:11], v[184:187], v[4:7]
    ds_read_b64_tr_b16 a[94:95], v43 offset:30720
    v_mul_f32 v29, v29, v1
    v_mfma_f32_16x16x32_bf16 v[4:7], a[4:7], v[164:167], v[4:7]
    s_waitcnt lgkmcnt(8)
    ds_read_b64_tr_b16 a[88:89], v43 offset:24576
    ds_read_b64_tr_b16 a[90:91], v43 offset:26624
    v_mfma_f32_16x16x32_bf16 v[4:7], a[0:3], v[160:163], v[4:7]
    ds_read_b64_tr_b16 a[84:85], v43 offset:20480
    v_mul_f32 v30, v30, v1
    v_mfma_f32_16x16x32_bf16 v[16:19], a[32:35], v[160:163], v[16:19]
    ds_read_b64_tr_b16 a[86:87], v43 offset:22528
    ds_read_b64_tr_b16 a[80:81], v43 offset:16384
    v_mfma_f32_16x16x32_bf16 v[16:19], a[36:39], v[164:167], v[16:19]
    ds_read_b64_tr_b16 a[82:83], v43 offset:18432
    v_mul_f32 v31, v31, v1
    v_mfma_f32_16x16x32_bf16 v[16:19], a[40:43], v[184:187], v[16:19]
    ds_read_b64_tr_b16 a[76:77], v43 offset:12288
    ds_read_b64_tr_b16 a[78:79], v43 offset:14336
    v_mfma_f32_16x16x32_bf16 v[16:19], a[44:47], v[188:191], v[16:19]
    s_xor_b32 s69, s31, 0
    buffer_store_dwordx4 a[208:211], v63, s[24:27], s69 offen offset:0 nt
    v_mfma_f32_16x16x32_bf16 v[16:19], a[48:51], v[208:211], v[16:19]
    s_waitcnt lgkmcnt(9)
    ds_read_b64_tr_b16 a[72:73], v43 offset:8192
    ds_read_b64_tr_b16 a[74:75], v43 offset:10240
    v_mfma_f32_16x16x32_bf16 v[16:19], a[52:55], v[212:215], v[16:19]
    ds_read_b64_tr_b16 a[68:69], v43 offset:4096
    v_cvt_pk_bf16_f32 v28, v28, v29
    v_mfma_f32_16x16x32_bf16 v[16:19], a[56:59], v[232:235], v[16:19]
    ds_read_b64_tr_b16 a[70:71], v43 offset:6144
    ds_read_b64_tr_b16 a[64:65], v43 offset:0
    v_mfma_f32_16x16x32_bf16 v[16:19], a[60:63], v[236:239], v[16:19]
    s_waitcnt lgkmcnt(10)
    ds_read_b64_tr_b16 a[66:67], v43 offset:2048
    v_cvt_pk_bf16_f32 v29, v30, v31
    v_mfma_f32_16x16x32_bf16 v[64:67], a[92:95], v[236:239], v[64:67]
    v_mul_f32 v4, v4, v1
    v_mul_f32 v5, v5, v1
    v_mfma_f32_16x16x32_bf16 v[64:67], a[88:91], v[232:235], v[64:67]
    s_waitcnt lgkmcnt(8)
    v_mul_f32 v6, v6, v1
    v_mul_f32 v7, v7, v1
    v_mfma_f32_16x16x32_bf16 v[64:67], a[84:87], v[212:215], v[64:67]
    ds_read_b128 v[56:59], v54
    v_cvt_pk_bf16_f32 v30, v4, v5
    v_mfma_f32_16x16x32_bf16 v[64:67], a[80:83], v[208:211], v[64:67]
    s_waitcnt lgkmcnt(7)
    v_cvt_pk_bf16_f32 v31, v6, v7
    v_mul_f32 v16, v16, v1
    v_mfma_f32_16x16x32_bf16 v[64:67], a[76:79], v[188:191], v[64:67]
    s_waitcnt lgkmcnt(5)
    v_mul_f32 v17, v17, v1
    v_mul_f32 v18, v18, v1
    v_mfma_f32_16x16x32_bf16 v[64:67], a[72:75], v[184:187], v[64:67]
    s_waitcnt lgkmcnt(1)
    v_permlane16_swap_b32 v28, v30
    v_mfma_f32_16x16x32_bf16 v[64:67], a[68:71], v[164:167], v[64:67]
    s_xor_b32 s69, s31, 128
    buffer_store_dwordx4 a[232:235], v63, s[24:27], s69 offen offset:0 nt
    v_mfma_f32_16x16x32_bf16 v[64:67], a[64:67], v[160:163], v[64:67]
    v_permlane16_swap_b32 v29, v31
    v_mfma_f32_16x16x32_bf16 v[32:35], a[96:99], v[168:171], v[32:35]
    v_mul_f32 v19, v19, v1
    v_cvt_pk_bf16_f32 v16, v16, v17
    v_mfma_f32_16x16x32_bf16 v[32:35], a[100:103], v[172:175], v[32:35]
    v_cvt_pk_bf16_f32 v17, v18, v19
    v_mfma_f32_16x16x32_bf16 v[32:35], a[104:107], v[192:195], v[32:35]
    v_mfma_f32_16x16x32_bf16 v[32:35], a[108:111], v[196:199], v[32:35]
    v_mul_f32 v64, v64, v1
    v_mul_f32 v65, v65, v1
    v_mfma_f32_16x16x32_bf16 v[32:35], a[112:115], v[216:219], v[32:35]
    v_mul_f32 v66, v66, v1
    v_mul_f32 v67, v67, v1
    v_mfma_f32_16x16x32_bf16 v[32:35], a[116:119], v[220:223], v[32:35]
    s_waitcnt lgkmcnt(0)
    v_cvt_pk_bf16_f32 v18, v64, v65
    v_or_b32 v56, v56, v57
    v_mfma_f32_16x16x32_bf16 v[32:35], a[120:123], v[240:243], v[32:35]
    v_cvt_pk_bf16_f32 v19, v66, v67
    v_or3_b32 v56, v56, v58, v59
    v_mfma_f32_16x16x32_bf16 v[32:35], a[124:127], v[244:247], v[32:35]
    v_readfirstlane_b32 s66, v56
    v_mfma_f32_16x16x32_bf16 v[8:11], a[28:31], v[244:247], v[8:11]
    v_permlane16_swap_b32 v16, v18
    v_mfma_f32_16x16x32_bf16 v[8:11], a[24:27], v[240:243], v[8:11]
    s_min_u32 s66, s66, 1
    v_permlane16_swap_b32 v17, v19
    v_mfma_f32_16x16x32_bf16 v[8:11], a[20:23], v[220:223], v[8:11]
    v_mfma_f32_16x16x32_bf16 v[8:11], a[16:19], v[216:219], v[8:11]
    s_mov_b64 vcc, s[70:71]
    v_cndmask_b32_dpp v64, v16, v28, vcc quad_perm:[1,0,3,2] row_mask:0xf bank_mask:0xf
    v_mfma_f32_16x16x32_bf16 v[8:11], a[12:15], v[196:199], v[8:11]
    v_cndmask_b32_dpp v65, v17, v29, vcc quad_perm:[1,0,3,2] row_mask:0xf bank_mask:0xf
    v_mul_f32 v32, v32, v2
    v_mfma_f32_16x16x32_bf16 v[8:11], a[8:11], v[192:195], v[8:11]
    v_cndmask_b32_dpp v66, v18, v30, vcc quad_perm:[1,0,3,2] row_mask:0xf bank_mask:0xf
    v_mul_f32 v33, v33, v2
    v_mfma_f32_16x16x32_bf16 v[8:11], a[4:7], v[172:175], v[8:11]
    v_cndmask_b32_dpp v67, v19, v31, vcc quad_perm:[1,0,3,2] row_mask:0xf bank_mask:0xf
    v_mul_f32 v34, v34, v2
    v_mfma_f32_16x16x32_bf16 v[8:11], a[0:3], v[168:171], v[8:11]
    s_xor_b32 s69, s31, 384
    buffer_store_dwordx4 v[64:67], v63, s[24:27], s69 offen offset:0 nt
    v_mfma_f32_16x16x32_bf16 v[20:23], a[32:35], v[168:171], v[20:23]
    s_not_b64 vcc, s[70:71]
    v_cndmask_b32_dpp v16, v28, v16, vcc quad_perm:[1,0,3,2] row_mask:0xf bank_mask:0xf
    v_mul_f32 v35, v35, v2
    v_mfma_f32_16x16x32_bf16 v[20:23], a[36:39], v[172:175], v[20:23]
    v_cndmask_b32_dpp v17, v29, v17, vcc quad_perm:[1,0,3,2] row_mask:0xf bank_mask:0xf
    v_mfma_f32_16x16x32_bf16 v[20:23], a[40:43], v[192:195], v[20:23]
    v_cndmask_b32_dpp v18, v30, v18, vcc quad_perm:[1,0,3,2] row_mask:0xf bank_mask:0xf
    v_mfma_f32_16x16x32_bf16 v[20:23], a[44:47], v[196:199], v[20:23]
    v_cndmask_b32_dpp v19, v31, v19, vcc quad_perm:[1,0,3,2] row_mask:0xf bank_mask:0xf
    v_mfma_f32_16x16x32_bf16 v[20:23], a[48:51], v[216:219], v[20:23]
    v_cvt_pk_bf16_f32 v32, v32, v33
    v_mfma_f32_16x16x32_bf16 v[20:23], a[52:55], v[220:223], v[20:23]
    v_cvt_pk_bf16_f32 v33, v34, v35
    v_mul_f32 v8, v8, v2
    v_mfma_f32_16x16x32_bf16 v[20:23], a[56:59], v[240:243], v[20:23]
    v_mul_f32 v9, v9, v2
    v_mul_f32 v10, v10, v2
    v_mfma_f32_16x16x32_bf16 v[20:23], a[60:63], v[244:247], v[20:23]
    v_mul_f32 v11, v11, v2
    v_cvt_pk_bf16_f32 v34, v8, v9
    v_mfma_f32_16x16x32_bf16 v[68:71], a[92:95], v[244:247], v[68:71]
    v_cvt_pk_bf16_f32 v35, v10, v11
    v_mfma_f32_16x16x32_bf16 v[68:71], a[88:91], v[240:243], v[68:71]
    v_mfma_f32_16x16x32_bf16 v[68:71], a[84:87], v[220:223], v[68:71]
    v_permlane16_swap_b32 v32, v34
    v_mfma_f32_16x16x32_bf16 v[68:71], a[80:83], v[216:219], v[68:71]
    s_xor_b32 s69, s31, 384
    buffer_store_dwordx4 v[16:19], v63, s[24:27], s69 offen offset:512 nt
    v_mfma_f32_16x16x32_bf16 v[68:71], a[76:79], v[196:199], v[68:71]
    v_permlane16_swap_b32 v33, v35
    v_mfma_f32_16x16x32_bf16 v[68:71], a[72:75], v[192:195], v[68:71]
    v_mul_f32 v20, v20, v2
    v_mul_f32 v21, v21, v2
    v_mfma_f32_16x16x32_bf16 v[68:71], a[68:71], v[172:175], v[68:71]
    v_mul_f32 v22, v22, v2
    v_mul_f32 v23, v23, v2
    v_mfma_f32_16x16x32_bf16 v[68:71], a[64:67], v[168:171], v[68:71]
    v_cvt_pk_bf16_f32 v20, v20, v21
    v_mfma_f32_16x16x32_bf16 v[36:39], a[96:99], v[176:179], v[36:39]
    v_cvt_pk_bf16_f32 v21, v22, v23
    v_mfma_f32_16x16x32_bf16 v[36:39], a[100:103], v[180:183], v[36:39]
    v_mfma_f32_16x16x32_bf16 v[36:39], a[104:107], v[200:203], v[36:39]
    v_mfma_f32_16x16x32_bf16 v[36:39], a[108:111], v[204:207], v[36:39]
    v_mfma_f32_16x16x32_bf16 v[36:39], a[112:115], v[224:227], v[36:39]
    v_mfma_f32_16x16x32_bf16 v[36:39], a[116:119], v[228:231], v[36:39]
    v_mul_f32 v68, v68, v2
    v_mul_f32 v69, v69, v2
    v_mfma_f32_16x16x32_bf16 v[36:39], a[120:123], v[248:251], v[36:39]
    v_mul_f32 v70, v70, v2
    v_mul_f32 v71, v71, v2
    v_mfma_f32_16x16x32_bf16 v[36:39], a[124:127], v[252:255], v[36:39]
    v_cvt_pk_bf16_f32 v22, v68, v69
    v_mfma_f32_16x16x32_bf16 v[12:15], a[28:31], v[252:255], v[12:15]
    v_cvt_pk_bf16_f32 v23, v70, v71
    v_mfma_f32_16x16x32_bf16 v[12:15], a[24:27], v[248:251], v[12:15]
    v_mfma_f32_16x16x32_bf16 v[12:15], a[20:23], v[228:231], v[12:15]
    v_permlane16_swap_b32 v20, v22
    v_mfma_f32_16x16x32_bf16 v[12:15], a[16:19], v[224:227], v[12:15]
    v_permlane16_swap_b32 v21, v23
    v_mfma_f32_16x16x32_bf16 v[12:15], a[12:15], v[204:207], v[12:15]
    v_mul_f32 v36, v36, v3
    v_mul_f32 v37, v37, v3
    v_mfma_f32_16x16x32_bf16 v[12:15], a[8:11], v[200:203], v[12:15]
    s_mov_b64 vcc, s[70:71]
    v_cndmask_b32_dpp v68, v20, v32, vcc quad_perm:[1,0,3,2] row_mask:0xf bank_mask:0xf
    v_mul_f32 v38, v38, v3
    v_mfma_f32_16x16x32_bf16 v[12:15], a[4:7], v[180:183], v[12:15]
    v_cndmask_b32_dpp v69, v21, v33, vcc quad_perm:[1,0,3,2] row_mask:0xf bank_mask:0xf
    v_mul_f32 v39, v39, v3
    v_mfma_f32_16x16x32_bf16 v[12:15], a[0:3], v[176:179], v[12:15]
    v_cndmask_b32_dpp v70, v22, v34, vcc quad_perm:[1,0,3,2] row_mask:0xf bank_mask:0xf
    v_mfma_f32_16x16x32_bf16 v[24:27], a[32:35], v[176:179], v[24:27]
    v_cndmask_b32_dpp v71, v23, v35, vcc quad_perm:[1,0,3,2] row_mask:0xf bank_mask:0xf
    v_mfma_f32_16x16x32_bf16 v[24:27], a[36:39], v[180:183], v[24:27]
    s_xor_b32 s69, s33, 384
    buffer_store_dwordx4 v[68:71], v63, s[24:27], s69 offen offset:0 nt
    v_mfma_f32_16x16x32_bf16 v[24:27], a[40:43], v[200:203], v[24:27]
    s_not_b64 vcc, s[70:71]
    v_cndmask_b32_dpp v20, v32, v20, vcc quad_perm:[1,0,3,2] row_mask:0xf bank_mask:0xf
    v_mfma_f32_16x16x32_bf16 v[24:27], a[44:47], v[204:207], v[24:27]
    v_cndmask_b32_dpp v21, v33, v21, vcc quad_perm:[1,0,3,2] row_mask:0xf bank_mask:0xf
    v_mfma_f32_16x16x32_bf16 v[24:27], a[48:51], v[224:227], v[24:27]
    v_cndmask_b32_dpp v22, v34, v22, vcc quad_perm:[1,0,3,2] row_mask:0xf bank_mask:0xf
    v_mfma_f32_16x16x32_bf16 v[24:27], a[52:55], v[228:231], v[24:27]
    v_cndmask_b32_dpp v23, v35, v23, vcc quad_perm:[1,0,3,2] row_mask:0xf bank_mask:0xf
    v_mfma_f32_16x16x32_bf16 v[24:27], a[56:59], v[248:251], v[24:27]
    v_cvt_pk_bf16_f32 v36, v36, v37
    v_mfma_f32_16x16x32_bf16 v[24:27], a[60:63], v[252:255], v[24:27]
    v_cvt_pk_bf16_f32 v37, v38, v39
    v_mul_f32 v12, v12, v3
    v_mfma_f32_16x16x32_bf16 v[72:75], a[92:95], v[252:255], v[72:75]
    v_mul_f32 v13, v13, v3
    v_mul_f32 v14, v14, v3
    v_mfma_f32_16x16x32_bf16 v[72:75], a[88:91], v[248:251], v[72:75]
    v_mul_f32 v15, v15, v3
    v_cvt_pk_bf16_f32 v38, v12, v13
    v_mfma_f32_16x16x32_bf16 v[72:75], a[84:87], v[228:231], v[72:75]
    v_cvt_pk_bf16_f32 v39, v14, v15
    v_mul_f32 v24, v24, v3
    v_mfma_f32_16x16x32_bf16 v[72:75], a[80:83], v[224:227], v[72:75]
    v_mul_f32 v25, v25, v3
    v_mul_f32 v26, v26, v3
    v_mfma_f32_16x16x32_bf16 v[72:75], a[76:79], v[204:207], v[72:75]
    v_permlane16_swap_b32 v36, v38
    v_mfma_f32_16x16x32_bf16 v[72:75], a[72:75], v[200:203], v[72:75]
    s_xor_b32 s69, s33, 384
    buffer_store_dwordx4 v[20:23], v63, s[24:27], s69 offen offset:512 nt
    v_mfma_f32_16x16x32_bf16 v[72:75], a[68:71], v[180:183], v[72:75]
    v_permlane16_swap_b32 v37, v39
    v_mfma_f32_16x16x32_bf16 v[72:75], a[64:67], v[176:179], v[72:75]
    v_mul_f32 v27, v27, v3
    v_cvt_pk_bf16_f32 v24, v24, v25
    v_cvt_pk_bf16_f32 v25, v26, v27
    s_nop 4
    v_mul_f32 v72, v72, v3
    v_mul_f32 v73, v73, v3
    v_mul_f32 v74, v74, v3
    v_mul_f32 v75, v75, v3
    v_cvt_pk_bf16_f32 v26, v72, v73
    v_cvt_pk_bf16_f32 v27, v74, v75
    s_nop 0
    v_permlane16_swap_b32 v24, v26
    v_permlane16_swap_b32 v25, v27
    s_mov_b64 vcc, s[70:71]
    v_cndmask_b32_dpp v72, v24, v36, vcc quad_perm:[1,0,3,2] row_mask:0xf bank_mask:0xf
    v_cndmask_b32_dpp v73, v25, v37, vcc quad_perm:[1,0,3,2] row_mask:0xf bank_mask:0xf
    v_cndmask_b32_dpp v74, v26, v38, vcc quad_perm:[1,0,3,2] row_mask:0xf bank_mask:0xf
    v_cndmask_b32_dpp v75, v27, v39, vcc quad_perm:[1,0,3,2] row_mask:0xf bank_mask:0xf
    s_xor_b32 s69, s35, 384
    buffer_store_dwordx4 v[72:75], v63, s[24:27], s69 offen offset:0 nt
    s_not_b64 vcc, s[70:71]
    v_cndmask_b32_dpp v24, v36, v24, vcc quad_perm:[1,0,3,2] row_mask:0xf bank_mask:0xf
    v_cndmask_b32_dpp v25, v37, v25, vcc quad_perm:[1,0,3,2] row_mask:0xf bank_mask:0xf
    v_cndmask_b32_dpp v26, v38, v26, vcc quad_perm:[1,0,3,2] row_mask:0xf bank_mask:0xf
    v_cndmask_b32_dpp v27, v39, v27, vcc quad_perm:[1,0,3,2] row_mask:0xf bank_mask:0xf
    s_xor_b32 s69, s35, 384
    buffer_store_dwordx4 v[24:27], v63, s[24:27], s69 offen offset:512 nt
    s_cmp_gt_u32 s66, s37
    s_cbranch_scc1 L_redo
L_end:
    s_endpgm
L_redo:
    s_mov_b32 s37, 1
    s_waitcnt vmcnt(0) lgkmcnt(0)
    v_and_b32 v4, 15, v0
    v_lshrrev_b32 v5, 4, v0
    v_lshlrev_b32 v5, 4, v5
    v_lshl_or_b32 v4, v4, 9, v5
    v_mov_b32 v252, 0xff800000
    v_mov_b32 v253, 0xff800000
    v_mov_b32 v254, 0xff800000
    buffer_load_dwordx4 v[64:67], v4, s[12:15], s30 offen offset:0
    buffer_load_dwordx4 v[68:71], v4, s[12:15], s30 offen offset:64
    buffer_load_dwordx4 v[72:75], v4, s[12:15], s30 offen offset:128
    buffer_load_dwordx4 v[76:79], v4, s[12:15], s30 offen offset:192
    buffer_load_dwordx4 v[80:83], v4, s[12:15], s30 offen offset:256
    buffer_load_dwordx4 v[84:87], v4, s[12:15], s30 offen offset:320
    buffer_load_dwordx4 v[88:91], v4, s[12:15], s30 offen offset:384
    buffer_load_dwordx4 v[92:95], v4, s[12:15], s30 offen offset:448
    s_waitcnt vmcnt(0)
    v_lshlrev_b32 v100, 16, v64
    v_and_b32 v101, s3, v64
    v_pk_mul_f32 v[100:101], v[100:101], s[38:39]
    v_cvt_pk_bf16_f32 v100, v100, v101
    v_accvgpr_write_b32 a0, v100
    v_lshlrev_b32 v100, 16, v65
    v_and_b32 v101, s3, v65
    v_pk_mul_f32 v[100:101], v[100:101], s[38:39]
    v_cvt_pk_bf16_f32 v100, v100, v101
    v_accvgpr_write_b32 a1, v100
    v_lshlrev_b32 v100, 16, v66
    v_and_b32 v101, s3, v66
    v_pk_mul_f32 v[100:101], v[100:101], s[38:39]
    v_cvt_pk_bf16_f32 v100, v100, v101
    v_accvgpr_write_b32 a2, v100
    v_lshlrev_b32 v100, 16, v67
    v_and_b32 v101, s3, v67
    v_pk_mul_f32 v[100:101], v[100:101], s[38:39]
    v_cvt_pk_bf16_f32 v100, v100, v101
    v_accvgpr_write_b32 a3, v100
    v_lshlrev_b32 v100, 16, v68
    v_and_b32 v101, s3, v68
    v_pk_mul_f32 v[100:101], v[100:101], s[38:39]
    v_cvt_pk_bf16_f32 v100, v100, v101
    v_accvgpr_write_b32 a4, v100
    v_lshlrev_b32 v100, 16, v69
    v_and_b32 v101, s3, v69
    v_pk_mul_f32 v[100:101], v[100:101], s[38:39]
    v_cvt_pk_bf16_f32 v100, v100, v101
    v_accvgpr_write_b32 a5, v100
    v_lshlrev_b32 v100, 16, v70
    v_and_b32 v101, s3, v70
    v_pk_mul_f32 v[100:101], v[100:101], s[38:39]
    v_cvt_pk_bf16_f32 v100, v100, v101
    v_accvgpr_write_b32 a6, v100
    v_lshlrev_b32 v100, 16, v71
    v_and_b32 v101, s3, v71
    v_pk_mul_f32 v[100:101], v[100:101], s[38:39]
    v_cvt_pk_bf16_f32 v100, v100, v101
    v_accvgpr_write_b32 a7, v100
    v_lshlrev_b32 v100, 16, v72
    v_and_b32 v101, s3, v72
    v_pk_mul_f32 v[100:101], v[100:101], s[38:39]
    v_cvt_pk_bf16_f32 v100, v100, v101
    v_accvgpr_write_b32 a8, v100
    v_lshlrev_b32 v100, 16, v73
    v_and_b32 v101, s3, v73
    v_pk_mul_f32 v[100:101], v[100:101], s[38:39]
    v_cvt_pk_bf16_f32 v100, v100, v101
    v_accvgpr_write_b32 a9, v100
    v_lshlrev_b32 v100, 16, v74
    v_and_b32 v101, s3, v74
    v_pk_mul_f32 v[100:101], v[100:101], s[38:39]
    v_cvt_pk_bf16_f32 v100, v100, v101
    v_accvgpr_write_b32 a10, v100
    v_lshlrev_b32 v100, 16, v75
    v_and_b32 v101, s3, v75
    v_pk_mul_f32 v[100:101], v[100:101], s[38:39]
    v_cvt_pk_bf16_f32 v100, v100, v101
    v_accvgpr_write_b32 a11, v100
    v_lshlrev_b32 v100, 16, v76
    v_and_b32 v101, s3, v76
    v_pk_mul_f32 v[100:101], v[100:101], s[38:39]
    v_cvt_pk_bf16_f32 v100, v100, v101
    v_accvgpr_write_b32 a12, v100
    v_lshlrev_b32 v100, 16, v77
    v_and_b32 v101, s3, v77
    v_pk_mul_f32 v[100:101], v[100:101], s[38:39]
    v_cvt_pk_bf16_f32 v100, v100, v101
    v_accvgpr_write_b32 a13, v100
    v_lshlrev_b32 v100, 16, v78
    v_and_b32 v101, s3, v78
    v_pk_mul_f32 v[100:101], v[100:101], s[38:39]
    v_cvt_pk_bf16_f32 v100, v100, v101
    v_accvgpr_write_b32 a14, v100
    v_lshlrev_b32 v100, 16, v79
    v_and_b32 v101, s3, v79
    v_pk_mul_f32 v[100:101], v[100:101], s[38:39]
    v_cvt_pk_bf16_f32 v100, v100, v101
    v_accvgpr_write_b32 a15, v100
    v_lshlrev_b32 v100, 16, v80
    v_and_b32 v101, s3, v80
    v_pk_mul_f32 v[100:101], v[100:101], s[38:39]
    v_cvt_pk_bf16_f32 v100, v100, v101
    v_accvgpr_write_b32 a16, v100
    v_lshlrev_b32 v100, 16, v81
    v_and_b32 v101, s3, v81
    v_pk_mul_f32 v[100:101], v[100:101], s[38:39]
    v_cvt_pk_bf16_f32 v100, v100, v101
    v_accvgpr_write_b32 a17, v100
    v_lshlrev_b32 v100, 16, v82
    v_and_b32 v101, s3, v82
    v_pk_mul_f32 v[100:101], v[100:101], s[38:39]
    v_cvt_pk_bf16_f32 v100, v100, v101
    v_accvgpr_write_b32 a18, v100
    v_lshlrev_b32 v100, 16, v83
    v_and_b32 v101, s3, v83
    v_pk_mul_f32 v[100:101], v[100:101], s[38:39]
    v_cvt_pk_bf16_f32 v100, v100, v101
    v_accvgpr_write_b32 a19, v100
    v_lshlrev_b32 v100, 16, v84
    v_and_b32 v101, s3, v84
    v_pk_mul_f32 v[100:101], v[100:101], s[38:39]
    v_cvt_pk_bf16_f32 v100, v100, v101
    v_accvgpr_write_b32 a20, v100
    v_lshlrev_b32 v100, 16, v85
    v_and_b32 v101, s3, v85
    v_pk_mul_f32 v[100:101], v[100:101], s[38:39]
    v_cvt_pk_bf16_f32 v100, v100, v101
    v_accvgpr_write_b32 a21, v100
    v_lshlrev_b32 v100, 16, v86
    v_and_b32 v101, s3, v86
    v_pk_mul_f32 v[100:101], v[100:101], s[38:39]
    v_cvt_pk_bf16_f32 v100, v100, v101
    v_accvgpr_write_b32 a22, v100
    v_lshlrev_b32 v100, 16, v87
    v_and_b32 v101, s3, v87
    v_pk_mul_f32 v[100:101], v[100:101], s[38:39]
    v_cvt_pk_bf16_f32 v100, v100, v101
    v_accvgpr_write_b32 a23, v100
    v_lshlrev_b32 v100, 16, v88
    v_and_b32 v101, s3, v88
    v_pk_mul_f32 v[100:101], v[100:101], s[38:39]
    v_cvt_pk_bf16_f32 v100, v100, v101
    v_accvgpr_write_b32 a24, v100
    v_lshlrev_b32 v100, 16, v89
    v_and_b32 v101, s3, v89
    v_pk_mul_f32 v[100:101], v[100:101], s[38:39]
    v_cvt_pk_bf16_f32 v100, v100, v101
    v_accvgpr_write_b32 a25, v100
    v_lshlrev_b32 v100, 16, v90
    v_and_b32 v101, s3, v90
    v_pk_mul_f32 v[100:101], v[100:101], s[38:39]
    v_cvt_pk_bf16_f32 v100, v100, v101
    v_accvgpr_write_b32 a26, v100
    v_lshlrev_b32 v100, 16, v91
    v_and_b32 v101, s3, v91
    v_pk_mul_f32 v[100:101], v[100:101], s[38:39]
    v_cvt_pk_bf16_f32 v100, v100, v101
    v_accvgpr_write_b32 a27, v100
    v_lshlrev_b32 v100, 16, v92
    v_and_b32 v101, s3, v92
    v_pk_mul_f32 v[100:101], v[100:101], s[38:39]
    v_cvt_pk_bf16_f32 v100, v100, v101
    v_accvgpr_write_b32 a28, v100
    v_lshlrev_b32 v100, 16, v93
    v_and_b32 v101, s3, v93
    v_pk_mul_f32 v[100:101], v[100:101], s[38:39]
    v_cvt_pk_bf16_f32 v100, v100, v101
    v_accvgpr_write_b32 a29, v100
    v_lshlrev_b32 v100, 16, v94
    v_and_b32 v101, s3, v94
    v_pk_mul_f32 v[100:101], v[100:101], s[38:39]
    v_cvt_pk_bf16_f32 v100, v100, v101
    v_accvgpr_write_b32 a30, v100
    v_lshlrev_b32 v100, 16, v95
    v_and_b32 v101, s3, v95
    v_pk_mul_f32 v[100:101], v[100:101], s[38:39]
    v_cvt_pk_bf16_f32 v100, v100, v101
    v_accvgpr_write_b32 a31, v100
    buffer_load_dwordx4 v[64:67], v4, s[12:15], s32 offen offset:0
    buffer_load_dwordx4 v[68:71], v4, s[12:15], s32 offen offset:64
    buffer_load_dwordx4 v[72:75], v4, s[12:15], s32 offen offset:128
    buffer_load_dwordx4 v[76:79], v4, s[12:15], s32 offen offset:192
    buffer_load_dwordx4 v[80:83], v4, s[12:15], s32 offen offset:256
    buffer_load_dwordx4 v[84:87], v4, s[12:15], s32 offen offset:320
    buffer_load_dwordx4 v[88:91], v4, s[12:15], s32 offen offset:384
    buffer_load_dwordx4 v[92:95], v4, s[12:15], s32 offen offset:448
    s_waitcnt vmcnt(0)
    v_lshlrev_b32 v100, 16, v64
    v_and_b32 v101, s3, v64
    v_pk_mul_f32 v[100:101], v[100:101], s[38:39]
    v_cvt_pk_bf16_f32 v100, v100, v101
    v_accvgpr_write_b32 a32, v100
    v_lshlrev_b32 v100, 16, v65
    v_and_b32 v101, s3, v65
    v_pk_mul_f32 v[100:101], v[100:101], s[38:39]
    v_cvt_pk_bf16_f32 v100, v100, v101
    v_accvgpr_write_b32 a33, v100
    v_lshlrev_b32 v100, 16, v66
    v_and_b32 v101, s3, v66
    v_pk_mul_f32 v[100:101], v[100:101], s[38:39]
    v_cvt_pk_bf16_f32 v100, v100, v101
    v_accvgpr_write_b32 a34, v100
    v_lshlrev_b32 v100, 16, v67
    v_and_b32 v101, s3, v67
    v_pk_mul_f32 v[100:101], v[100:101], s[38:39]
    v_cvt_pk_bf16_f32 v100, v100, v101
    v_accvgpr_write_b32 a35, v100
    v_lshlrev_b32 v100, 16, v68
    v_and_b32 v101, s3, v68
    v_pk_mul_f32 v[100:101], v[100:101], s[38:39]
    v_cvt_pk_bf16_f32 v100, v100, v101
    v_accvgpr_write_b32 a36, v100
    v_lshlrev_b32 v100, 16, v69
    v_and_b32 v101, s3, v69
    v_pk_mul_f32 v[100:101], v[100:101], s[38:39]
    v_cvt_pk_bf16_f32 v100, v100, v101
    v_accvgpr_write_b32 a37, v100
    v_lshlrev_b32 v100, 16, v70
    v_and_b32 v101, s3, v70
    v_pk_mul_f32 v[100:101], v[100:101], s[38:39]
    v_cvt_pk_bf16_f32 v100, v100, v101
    v_accvgpr_write_b32 a38, v100
    v_lshlrev_b32 v100, 16, v71
    v_and_b32 v101, s3, v71
    v_pk_mul_f32 v[100:101], v[100:101], s[38:39]
    v_cvt_pk_bf16_f32 v100, v100, v101
    v_accvgpr_write_b32 a39, v100
    v_lshlrev_b32 v100, 16, v72
    v_and_b32 v101, s3, v72
    v_pk_mul_f32 v[100:101], v[100:101], s[38:39]
    v_cvt_pk_bf16_f32 v100, v100, v101
    v_accvgpr_write_b32 a40, v100
    v_lshlrev_b32 v100, 16, v73
    v_and_b32 v101, s3, v73
    v_pk_mul_f32 v[100:101], v[100:101], s[38:39]
    v_cvt_pk_bf16_f32 v100, v100, v101
    v_accvgpr_write_b32 a41, v100
    v_lshlrev_b32 v100, 16, v74
    v_and_b32 v101, s3, v74
    v_pk_mul_f32 v[100:101], v[100:101], s[38:39]
    v_cvt_pk_bf16_f32 v100, v100, v101
    v_accvgpr_write_b32 a42, v100
    v_lshlrev_b32 v100, 16, v75
    v_and_b32 v101, s3, v75
    v_pk_mul_f32 v[100:101], v[100:101], s[38:39]
    v_cvt_pk_bf16_f32 v100, v100, v101
    v_accvgpr_write_b32 a43, v100
    v_lshlrev_b32 v100, 16, v76
    v_and_b32 v101, s3, v76
    v_pk_mul_f32 v[100:101], v[100:101], s[38:39]
    v_cvt_pk_bf16_f32 v100, v100, v101
    v_accvgpr_write_b32 a44, v100
    v_lshlrev_b32 v100, 16, v77
    v_and_b32 v101, s3, v77
    v_pk_mul_f32 v[100:101], v[100:101], s[38:39]
    v_cvt_pk_bf16_f32 v100, v100, v101
    v_accvgpr_write_b32 a45, v100
    v_lshlrev_b32 v100, 16, v78
    v_and_b32 v101, s3, v78
    v_pk_mul_f32 v[100:101], v[100:101], s[38:39]
    v_cvt_pk_bf16_f32 v100, v100, v101
    v_accvgpr_write_b32 a46, v100
    v_lshlrev_b32 v100, 16, v79
    v_and_b32 v101, s3, v79
    v_pk_mul_f32 v[100:101], v[100:101], s[38:39]
    v_cvt_pk_bf16_f32 v100, v100, v101
    v_accvgpr_write_b32 a47, v100
    v_lshlrev_b32 v100, 16, v80
    v_and_b32 v101, s3, v80
    v_pk_mul_f32 v[100:101], v[100:101], s[38:39]
    v_cvt_pk_bf16_f32 v100, v100, v101
    v_accvgpr_write_b32 a48, v100
    v_lshlrev_b32 v100, 16, v81
    v_and_b32 v101, s3, v81
    v_pk_mul_f32 v[100:101], v[100:101], s[38:39]
    v_cvt_pk_bf16_f32 v100, v100, v101
    v_accvgpr_write_b32 a49, v100
    v_lshlrev_b32 v100, 16, v82
    v_and_b32 v101, s3, v82
    v_pk_mul_f32 v[100:101], v[100:101], s[38:39]
    v_cvt_pk_bf16_f32 v100, v100, v101
    v_accvgpr_write_b32 a50, v100
    v_lshlrev_b32 v100, 16, v83
    v_and_b32 v101, s3, v83
    v_pk_mul_f32 v[100:101], v[100:101], s[38:39]
    v_cvt_pk_bf16_f32 v100, v100, v101
    v_accvgpr_write_b32 a51, v100
    v_lshlrev_b32 v100, 16, v84
    v_and_b32 v101, s3, v84
    v_pk_mul_f32 v[100:101], v[100:101], s[38:39]
    v_cvt_pk_bf16_f32 v100, v100, v101
    v_accvgpr_write_b32 a52, v100
    v_lshlrev_b32 v100, 16, v85
    v_and_b32 v101, s3, v85
    v_pk_mul_f32 v[100:101], v[100:101], s[38:39]
    v_cvt_pk_bf16_f32 v100, v100, v101
    v_accvgpr_write_b32 a53, v100
    v_lshlrev_b32 v100, 16, v86
    v_and_b32 v101, s3, v86
    v_pk_mul_f32 v[100:101], v[100:101], s[38:39]
    v_cvt_pk_bf16_f32 v100, v100, v101
    v_accvgpr_write_b32 a54, v100
    v_lshlrev_b32 v100, 16, v87
    v_and_b32 v101, s3, v87
    v_pk_mul_f32 v[100:101], v[100:101], s[38:39]
    v_cvt_pk_bf16_f32 v100, v100, v101
    v_accvgpr_write_b32 a55, v100
    v_lshlrev_b32 v100, 16, v88
    v_and_b32 v101, s3, v88
    v_pk_mul_f32 v[100:101], v[100:101], s[38:39]
    v_cvt_pk_bf16_f32 v100, v100, v101
    v_accvgpr_write_b32 a56, v100
    v_lshlrev_b32 v100, 16, v89
    v_and_b32 v101, s3, v89
    v_pk_mul_f32 v[100:101], v[100:101], s[38:39]
    v_cvt_pk_bf16_f32 v100, v100, v101
    v_accvgpr_write_b32 a57, v100
    v_lshlrev_b32 v100, 16, v90
    v_and_b32 v101, s3, v90
    v_pk_mul_f32 v[100:101], v[100:101], s[38:39]
    v_cvt_pk_bf16_f32 v100, v100, v101
    v_accvgpr_write_b32 a58, v100
    v_lshlrev_b32 v100, 16, v91
    v_and_b32 v101, s3, v91
    v_pk_mul_f32 v[100:101], v[100:101], s[38:39]
    v_cvt_pk_bf16_f32 v100, v100, v101
    v_accvgpr_write_b32 a59, v100
    v_lshlrev_b32 v100, 16, v92
    v_and_b32 v101, s3, v92
    v_pk_mul_f32 v[100:101], v[100:101], s[38:39]
    v_cvt_pk_bf16_f32 v100, v100, v101
    v_accvgpr_write_b32 a60, v100
    v_lshlrev_b32 v100, 16, v93
    v_and_b32 v101, s3, v93
    v_pk_mul_f32 v[100:101], v[100:101], s[38:39]
    v_cvt_pk_bf16_f32 v100, v100, v101
    v_accvgpr_write_b32 a61, v100
    v_lshlrev_b32 v100, 16, v94
    v_and_b32 v101, s3, v94
    v_pk_mul_f32 v[100:101], v[100:101], s[38:39]
    v_cvt_pk_bf16_f32 v100, v100, v101
    v_accvgpr_write_b32 a62, v100
    v_lshlrev_b32 v100, 16, v95
    v_and_b32 v101, s3, v95
    v_pk_mul_f32 v[100:101], v[100:101], s[38:39]
    v_cvt_pk_bf16_f32 v100, v100, v101
    v_accvgpr_write_b32 a63, v100
    buffer_load_dwordx4 v[64:67], v4, s[12:15], s34 offen offset:0
    buffer_load_dwordx4 v[68:71], v4, s[12:15], s34 offen offset:64
    buffer_load_dwordx4 v[72:75], v4, s[12:15], s34 offen offset:128
    buffer_load_dwordx4 v[76:79], v4, s[12:15], s34 offen offset:192
    buffer_load_dwordx4 v[80:83], v4, s[12:15], s34 offen offset:256
    buffer_load_dwordx4 v[84:87], v4, s[12:15], s34 offen offset:320
    buffer_load_dwordx4 v[88:91], v4, s[12:15], s34 offen offset:384
    buffer_load_dwordx4 v[92:95], v4, s[12:15], s34 offen offset:448
    s_waitcnt vmcnt(0)
    v_lshlrev_b32 v100, 16, v64
    v_and_b32 v101, s3, v64
    v_pk_mul_f32 v[100:101], v[100:101], s[38:39]
    v_cvt_pk_bf16_f32 v100, v100, v101
    v_accvgpr_write_b32 a64, v100
    v_lshlrev_b32 v100, 16, v65
    v_and_b32 v101, s3, v65
    v_pk_mul_f32 v[100:101], v[100:101], s[38:39]
    v_cvt_pk_bf16_f32 v100, v100, v101
    v_accvgpr_write_b32 a65, v100
    v_lshlrev_b32 v100, 16, v66
    v_and_b32 v101, s3, v66
    v_pk_mul_f32 v[100:101], v[100:101], s[38:39]
    v_cvt_pk_bf16_f32 v100, v100, v101
    v_accvgpr_write_b32 a66, v100
    v_lshlrev_b32 v100, 16, v67
    v_and_b32 v101, s3, v67
    v_pk_mul_f32 v[100:101], v[100:101], s[38:39]
    v_cvt_pk_bf16_f32 v100, v100, v101
    v_accvgpr_write_b32 a67, v100
    v_lshlrev_b32 v100, 16, v68
    v_and_b32 v101, s3, v68
    v_pk_mul_f32 v[100:101], v[100:101], s[38:39]
    v_cvt_pk_bf16_f32 v100, v100, v101
    v_accvgpr_write_b32 a68, v100
    v_lshlrev_b32 v100, 16, v69
    v_and_b32 v101, s3, v69
    v_pk_mul_f32 v[100:101], v[100:101], s[38:39]
    v_cvt_pk_bf16_f32 v100, v100, v101
    v_accvgpr_write_b32 a69, v100
    v_lshlrev_b32 v100, 16, v70
    v_and_b32 v101, s3, v70
    v_pk_mul_f32 v[100:101], v[100:101], s[38:39]
    v_cvt_pk_bf16_f32 v100, v100, v101
    v_accvgpr_write_b32 a70, v100
    v_lshlrev_b32 v100, 16, v71
    v_and_b32 v101, s3, v71
    v_pk_mul_f32 v[100:101], v[100:101], s[38:39]
    v_cvt_pk_bf16_f32 v100, v100, v101
    v_accvgpr_write_b32 a71, v100
    v_lshlrev_b32 v100, 16, v72
    v_and_b32 v101, s3, v72
    v_pk_mul_f32 v[100:101], v[100:101], s[38:39]
    v_cvt_pk_bf16_f32 v100, v100, v101
    v_accvgpr_write_b32 a72, v100
    v_lshlrev_b32 v100, 16, v73
    v_and_b32 v101, s3, v73
    v_pk_mul_f32 v[100:101], v[100:101], s[38:39]
    v_cvt_pk_bf16_f32 v100, v100, v101
    v_accvgpr_write_b32 a73, v100
    v_lshlrev_b32 v100, 16, v74
    v_and_b32 v101, s3, v74
    v_pk_mul_f32 v[100:101], v[100:101], s[38:39]
    v_cvt_pk_bf16_f32 v100, v100, v101
    v_accvgpr_write_b32 a74, v100
    v_lshlrev_b32 v100, 16, v75
    v_and_b32 v101, s3, v75
    v_pk_mul_f32 v[100:101], v[100:101], s[38:39]
    v_cvt_pk_bf16_f32 v100, v100, v101
    v_accvgpr_write_b32 a75, v100
    v_lshlrev_b32 v100, 16, v76
    v_and_b32 v101, s3, v76
    v_pk_mul_f32 v[100:101], v[100:101], s[38:39]
    v_cvt_pk_bf16_f32 v100, v100, v101
    v_accvgpr_write_b32 a76, v100
    v_lshlrev_b32 v100, 16, v77
    v_and_b32 v101, s3, v77
    v_pk_mul_f32 v[100:101], v[100:101], s[38:39]
    v_cvt_pk_bf16_f32 v100, v100, v101
    v_accvgpr_write_b32 a77, v100
    v_lshlrev_b32 v100, 16, v78
    v_and_b32 v101, s3, v78
    v_pk_mul_f32 v[100:101], v[100:101], s[38:39]
    v_cvt_pk_bf16_f32 v100, v100, v101
    v_accvgpr_write_b32 a78, v100
    v_lshlrev_b32 v100, 16, v79
    v_and_b32 v101, s3, v79
    v_pk_mul_f32 v[100:101], v[100:101], s[38:39]
    v_cvt_pk_bf16_f32 v100, v100, v101
    v_accvgpr_write_b32 a79, v100
    v_lshlrev_b32 v100, 16, v80
    v_and_b32 v101, s3, v80
    v_pk_mul_f32 v[100:101], v[100:101], s[38:39]
    v_cvt_pk_bf16_f32 v100, v100, v101
    v_accvgpr_write_b32 a80, v100
    v_lshlrev_b32 v100, 16, v81
    v_and_b32 v101, s3, v81
    v_pk_mul_f32 v[100:101], v[100:101], s[38:39]
    v_cvt_pk_bf16_f32 v100, v100, v101
    v_accvgpr_write_b32 a81, v100
    v_lshlrev_b32 v100, 16, v82
    v_and_b32 v101, s3, v82
    v_pk_mul_f32 v[100:101], v[100:101], s[38:39]
    v_cvt_pk_bf16_f32 v100, v100, v101
    v_accvgpr_write_b32 a82, v100
    v_lshlrev_b32 v100, 16, v83
    v_and_b32 v101, s3, v83
    v_pk_mul_f32 v[100:101], v[100:101], s[38:39]
    v_cvt_pk_bf16_f32 v100, v100, v101
    v_accvgpr_write_b32 a83, v100
    v_lshlrev_b32 v100, 16, v84
    v_and_b32 v101, s3, v84
    v_pk_mul_f32 v[100:101], v[100:101], s[38:39]
    v_cvt_pk_bf16_f32 v100, v100, v101
    v_accvgpr_write_b32 a84, v100
    v_lshlrev_b32 v100, 16, v85
    v_and_b32 v101, s3, v85
    v_pk_mul_f32 v[100:101], v[100:101], s[38:39]
    v_cvt_pk_bf16_f32 v100, v100, v101
    v_accvgpr_write_b32 a85, v100
    v_lshlrev_b32 v100, 16, v86
    v_and_b32 v101, s3, v86
    v_pk_mul_f32 v[100:101], v[100:101], s[38:39]
    v_cvt_pk_bf16_f32 v100, v100, v101
    v_accvgpr_write_b32 a86, v100
    v_lshlrev_b32 v100, 16, v87
    v_and_b32 v101, s3, v87
    v_pk_mul_f32 v[100:101], v[100:101], s[38:39]
    v_cvt_pk_bf16_f32 v100, v100, v101
    v_accvgpr_write_b32 a87, v100
    v_lshlrev_b32 v100, 16, v88
    v_and_b32 v101, s3, v88
    v_pk_mul_f32 v[100:101], v[100:101], s[38:39]
    v_cvt_pk_bf16_f32 v100, v100, v101
    v_accvgpr_write_b32 a88, v100
    v_lshlrev_b32 v100, 16, v89
    v_and_b32 v101, s3, v89
    v_pk_mul_f32 v[100:101], v[100:101], s[38:39]
    v_cvt_pk_bf16_f32 v100, v100, v101
    v_accvgpr_write_b32 a89, v100
    v_lshlrev_b32 v100, 16, v90
    v_and_b32 v101, s3, v90
    v_pk_mul_f32 v[100:101], v[100:101], s[38:39]
    v_cvt_pk_bf16_f32 v100, v100, v101
    v_accvgpr_write_b32 a90, v100
    v_lshlrev_b32 v100, 16, v91
    v_and_b32 v101, s3, v91
    v_pk_mul_f32 v[100:101], v[100:101], s[38:39]
    v_cvt_pk_bf16_f32 v100, v100, v101
    v_accvgpr_write_b32 a91, v100
    v_lshlrev_b32 v100, 16, v92
    v_and_b32 v101, s3, v92
    v_pk_mul_f32 v[100:101], v[100:101], s[38:39]
    v_cvt_pk_bf16_f32 v100, v100, v101
    v_accvgpr_write_b32 a92, v100
    v_lshlrev_b32 v100, 16, v93
    v_and_b32 v101, s3, v93
    v_pk_mul_f32 v[100:101], v[100:101], s[38:39]
    v_cvt_pk_bf16_f32 v100, v100, v101
    v_accvgpr_write_b32 a93, v100
    v_lshlrev_b32 v100, 16, v94
    v_and_b32 v101, s3, v94
    v_pk_mul_f32 v[100:101], v[100:101], s[38:39]
    v_cvt_pk_bf16_f32 v100, v100, v101
    v_accvgpr_write_b32 a94, v100
    v_lshlrev_b32 v100, 16, v95
    v_and_b32 v101, s3, v95
    v_pk_mul_f32 v[100:101], v[100:101], s[38:39]
    v_cvt_pk_bf16_f32 v100, v100, v101
    v_accvgpr_write_b32 a95, v100
    s_mov_b32 s66, 0
L_maxloop:
    buffer_load_dwordx4 v[64:67], v4, s[16:19], s66 offen offset:0
    buffer_load_dwordx4 v[68:71], v4, s[16:19], s66 offen offset:64
    buffer_load_dwordx4 v[72:75], v4, s[16:19], s66 offen offset:128
    buffer_load_dwordx4 v[76:79], v4, s[16:19], s66 offen offset:192
    buffer_load_dwordx4 v[80:83], v4, s[16:19], s66 offen offset:256
    buffer_load_dwordx4 v[84:87], v4, s[16:19], s66 offen offset:320
    buffer_load_dwordx4 v[88:91], v4, s[16:19], s66 offen offset:384
    buffer_load_dwordx4 v[92:95], v4, s[16:19], s66 offen offset:448
    s_waitcnt vmcnt(0)
    v_mfma_f32_16x16x32_bf16 v[100:103], v[64:67], a[0:3], 0
    v_mfma_f32_16x16x32_bf16 v[100:103], v[68:71], a[4:7], v[100:103]
    v_mfma_f32_16x16x32_bf16 v[100:103], v[72:75], a[8:11], v[100:103]
    v_mfma_f32_16x16x32_bf16 v[100:103], v[76:79], a[12:15], v[100:103]
    v_mfma_f32_16x16x32_bf16 v[100:103], v[80:83], a[16:19], v[100:103]
    v_mfma_f32_16x16x32_bf16 v[100:103], v[84:87], a[20:23], v[100:103]
    v_mfma_f32_16x16x32_bf16 v[100:103], v[88:91], a[24:27], v[100:103]
    v_mfma_f32_16x16x32_bf16 v[100:103], v[92:95], a[28:31], v[100:103]
    v_mfma_f32_16x16x32_bf16 v[104:107], v[64:67], a[32:35], 0
    v_mfma_f32_16x16x32_bf16 v[104:107], v[68:71], a[36:39], v[104:107]
    v_mfma_f32_16x16x32_bf16 v[104:107], v[72:75], a[40:43], v[104:107]
    v_mfma_f32_16x16x32_bf16 v[104:107], v[76:79], a[44:47], v[104:107]
    v_mfma_f32_16x16x32_bf16 v[104:107], v[80:83], a[48:51], v[104:107]
    v_mfma_f32_16x16x32_bf16 v[104:107], v[84:87], a[52:55], v[104:107]
    v_mfma_f32_16x16x32_bf16 v[104:107], v[88:91], a[56:59], v[104:107]
    v_mfma_f32_16x16x32_bf16 v[104:107], v[92:95], a[60:63], v[104:107]
    v_mfma_f32_16x16x32_bf16 v[108:111], v[64:67], a[64:67], 0
    v_mfma_f32_16x16x32_bf16 v[108:111], v[68:71], a[68:71], v[108:111]
    v_mfma_f32_16x16x32_bf16 v[108:111], v[72:75], a[72:75], v[108:111]
    v_mfma_f32_16x16x32_bf16 v[108:111], v[76:79], a[76:79], v[108:111]
    v_mfma_f32_16x16x32_bf16 v[108:111], v[80:83], a[80:83], v[108:111]
    v_mfma_f32_16x16x32_bf16 v[108:111], v[84:87], a[84:87], v[108:111]
    v_mfma_f32_16x16x32_bf16 v[108:111], v[88:91], a[88:91], v[108:111]
    v_mfma_f32_16x16x32_bf16 v[108:111], v[92:95], a[92:95], v[108:111]
    s_nop 7
    v_max3_f32 v252, v100, v101, v252
    v_max3_f32 v252, v102, v103, v252
    v_max3_f32 v253, v104, v105, v253
    v_max3_f32 v253, v106, v107, v253
    v_max3_f32 v254, v108, v109, v254
    v_max3_f32 v254, v110, v111, v254
    s_add_u32 s66, s66, 0x2000
    s_cmp_lt_u32 s66, 262144
    s_cbranch_scc1 L_maxloop
    s_barrier
    s_branch L_restart
.section .rodata,"a"
.p2align 6
.amdhsa_kernel standalone__mha_softmax__near_ridge_kernel
  .amdhsa_next_free_vgpr 512
  .amdhsa_next_free_sgpr 76
  .amdhsa_accum_offset 256
  .amdhsa_group_segment_fixed_size 0
  .amdhsa_kernarg_size 48
  .amdhsa_user_sgpr_count 2
  .amdhsa_user_sgpr_kernarg_segment_ptr 1
  .amdhsa_system_sgpr_workgroup_id_x 1
.end_amdhsa_kernel
```
